```python
import torch

def _softmax(x, axis=-1):
    return torch.softmax(x, dim=axis)
def _gelu(x):
    return torch.nn.functional.gelu(x, approximate="tanh")
def _silu(x):
    return torch.nn.functional.silu(x)
def _sigmoid(x):
    return torch.sigmoid(x)
def _layernorm(x, axis=-1, eps=1e-5):
    m = x.mean(dim=axis, keepdim=True)
    v = x.var(dim=axis, keepdim=True, unbiased=False)
    return (x - m) / torch.sqrt(v + eps)
def _scatter_add(tgt, idx, src, axis=0):
    return tgt.clone().index_add_(axis, idx, src)
def _segment_sum(src, seg, n):
    out = torch.zeros((n,) + src.shape[1:], dtype=src.dtype)
    return out.index_add_(0, seg, src)
def _pad(x, pw):
    flat = tuple(v for pair in reversed(pw) for v in pair)
    return torch.nn.functional.pad(x, flat)

kernel_name = 'sequential_preLN__gqa_block_cached__dense_activation_squared_relu__decode'

def setup_inputs():

    _w = (lambda a: (lambda t: t.to(torch.bfloat16) if t.is_floating_point() else t)(torch.as_tensor(a)))
    def _A_setup():
        B, Sq, D = 2, 1, 448
        Hq, Hkv, Sk, Dh = 16, 8, 32768, 256
        assert Hq % Hkv == 0, (Hq, Hkv)
        return {
            "x": _w((lambda *s: torch.randn(*s, dtype=torch.bfloat16) * 0.05)(B, Sq, D)),
            "k_cache": _w((lambda *s: torch.randn(*s, dtype=torch.bfloat16) * 3.2)(B, Hkv, Sk, Dh)),
            "v_cache": _w((lambda *s: torch.randn(*s, dtype=torch.bfloat16) * 0.4)(B, Hkv, Sk, Dh)),
            "wq": _w((lambda *s: torch.randn(*s, dtype=torch.bfloat16) * 3.2)(D, Hq * Dh) * (D ** -0.5)),
            "wo": _w((lambda *s: torch.randn(*s, dtype=torch.bfloat16) * 0.4)(Hq * Dh, D) * ((Hq * Dh) ** -0.5)),
        }
    _A_in = _A_setup()

    def _B_setup():
        B, S, D, F = 2, 1, 448, 1792
        return {
            "x": _w((lambda *s: torch.randn(*s, dtype=torch.bfloat16) * 0.05)(B, S, D)),
            "w1": _w((lambda *s: torch.randn(*s, dtype=torch.bfloat16) * 0.05)(D, F)),
            "b1": _w((lambda *s: torch.randn(*s, dtype=torch.bfloat16) * 0.8)(F)),
            "w2": _w((lambda *s: torch.randn(*s, dtype=torch.bfloat16) * 0.05)(F, D)),
            "b2": _w((lambda *s: torch.randn(*s, dtype=torch.bfloat16) * 3.2)(D)),
        }
    _B_in = _B_setup()

    return {
        "A_x": _A_in["x"],
        "A_k_cache": _A_in["k_cache"],
        "A_v_cache": _A_in["v_cache"],
        "A_wq": _A_in["wq"],
        "A_wo": _A_in["wo"],
        "B_x": _B_in["x"],
        "B_w1": _B_in["w1"],
        "B_b1": _B_in["b1"],
        "B_w2": _B_in["w2"],
        "B_b2": _B_in["b2"],
    }

def reference(A_x, A_k_cache, A_v_cache, A_wq, A_wo, B_x, B_w1, B_b1, B_w2, B_b2):
    def _A_ref(x, k_cache, v_cache, wq, wo):
        B, Sq, D = x.shape
        Hq, Dh = 16, 256
        Hkv = k_cache.shape[1]
        rep = Hq // Hkv
        q = (lambda x, *d: x.permute(*d))((x @ wq).reshape(B, Sq, Hq, Dh), 0, 2, 1, 3)
        k = (lambda x, n, axis: torch.repeat_interleave(x, n, dim=axis))(k_cache, rep, axis=1)
        v = (lambda x, n, axis: torch.repeat_interleave(x, n, dim=axis))(v_cache, rep, axis=1)
        scores = torch.einsum("bhqd,bhkd->bhqk", q, k) * (Dh ** -0.5)
        p = _softmax(scores, axis=-1)
        o = torch.einsum("bhqk,bhkd->bhqd", p, v)
        return (lambda x, *d: x.permute(*d))(o, 0, 2, 1, 3).reshape(B, Sq, Hq * Dh) @ wo

    def _B_ref(x, w1, b1, w2, b2):
        h = torch.einsum("bsd,df->bsf", x, w1) + b1
        zero = torch.zeros_like(h)
        r = torch.where(h > zero, h, zero)
        h = r * r
        out = torch.einsum("bsf,fd->bsd", h, w2) + b2
        return out

    x = A_x
    h = x + _A_ref(_layernorm(x, axis=-1), A_k_cache, A_v_cache, A_wq, A_wo)
    h2 = h + _B_ref(_layernorm(h, axis=-1), B_w1, B_b1, B_w2, B_b2)
    return h2
```

```asm
; @launch grid=(256,1,1) block=(256,1,1) lds=163840
.amdgcn_target "amdgcn-amd-amdhsa--gfx950"
.text
.globl sequential_preLN__gqa_block_cached__dense_activation_squared_relu__decode_kernel
.p2align 8
.type sequential_preLN__gqa_block_cached__dense_activation_squared_relu__decode_kernel,@function
sequential_preLN__gqa_block_cached__dense_activation_squared_relu__decode_kernel:
  s_cmp_ge_u32 s2, 256
  s_cbranch_scc1 L_end
  s_load_dwordx16 s[4:19], s[0:1], 0
  s_load_dwordx8 s[20:27], s[0:1], 64
  s_load_dwordx2 s[28:29], s[0:1], 96
  v_lshrrev_b32 v1, 6, v0
  v_and_b32 v0, 63, v0
  v_readfirstlane_b32 s3, v1
  v_and_b32 v60, 15, v0
  v_lshrrev_b32 v61, 4, v0
  s_cmp_lg_u32 s3, 0
  s_cbranch_scc1 L_help
  s_lshr_b32 s32, s2, 4
  s_add_u32 s76, s2, s32
  s_and_b32 s76, s76, 7
  s_and_b32 s60, s2, 8
  s_or_b32 s76, s76, s60
  s_lshl_b32 s56, s76, 24
  s_lshl_b32 s52, s32, 20
  s_mov_b32 s54, s52
  s_mov_b32 s38, 0x1000000
  s_mov_b32 s39, 0x20000
  v_and_b32 v44, 1, v0
  v_lshlrev_b32 v44, 4, v44
  v_lshl_add_u32 v44, v61, 5, v44
  v_bfe_u32 v3, v0, 1, 1
  v_lshl_add_u32 v44, v3, 11, v44
  v_bfe_u32 v3, v0, 2, 1
  v_lshl_add_u32 v44, v3, 9, v44
  v_bfe_u32 v3, v0, 3, 1
  v_lshl_add_u32 v44, v3, 10, v44
  v_add_u32 v45, 128, v44
  v_add_u32 v46, 32768, v44
  v_add_u32 v47, 32896, v44
  s_lshr_b32 s60, s2, 3
  s_sub_u32 s60, s60, 14
  s_bitcmp1_b32 s2, 1
  s_cselect_b32 s60, s60, 16
  s_mov_b32 s67, 0
  s_cmp_ge_u32 s60, 16
  s_cbranch_scc1 L_noq
  s_mov_b32 s67, 1
  s_and_b32 s61, s2, 1
  s_lshl_b32 s61, s61, 4
  s_add_u32 s60, s60, s61
  s_and_b32 s61, s2, 4
  s_lshl_b32 s61, s61, 3
  s_add_u32 s60, s60, s61
  s_lshl_b32 s65, s60, 7
  s_movk_i32 s66, 56
  s_mov_b32 m0, 0
  s_mov_b32 s46, 3670016
  s_mov_b32 s47, 0x20000
  v_and_b32 v8, 7, v0
  v_lshlrev_b32 v8, 4, v8
  v_and_b32 v9, 16, v0
  v_lshlrev_b32 v9, 1, v9
  v_xor_b32 v8, v8, v9
  v_lshrrev_b32 v9, 3, v0
  v_mul_u32_u24 v9, 8192, v9
  v_add_u32 v8, v8, v9
  v_xor_b32 v9, 64, v8
  s_waitcnt lgkmcnt(0)
  s_mov_b32 s44, s10
  s_and_b32 s45, s11, 0xffff
L_qdma:
  s_waitcnt vmcnt(30)
  buffer_load_dwordx4 v8, s[44:47], s65 offen offset:0  lds
  s_add_u32 s65, s65, 64512
  buffer_load_dwordx4 v9, s[44:47], s65 offen offset:1024  lds
  s_add_u32 s65, s65, 64512
  s_waitcnt vmcnt(30)
  buffer_load_dwordx4 v8, s[44:47], s65 offen offset:2048  lds
  s_add_u32 s65, s65, 64512
  buffer_load_dwordx4 v9, s[44:47], s65 offen offset:3072  lds
  s_add_u32 s65, s65, 68608
  s_add_u32 m0, m0, 4096
  s_waitcnt vmcnt(30)
  buffer_load_dwordx4 v8, s[44:47], s65 offen offset:0  lds
  s_add_u32 s65, s65, 64512
  buffer_load_dwordx4 v9, s[44:47], s65 offen offset:1024  lds
  s_add_u32 s65, s65, 64512
  s_waitcnt vmcnt(30)
  buffer_load_dwordx4 v8, s[44:47], s65 offen offset:2048  lds
  s_add_u32 s65, s65, 64512
  buffer_load_dwordx4 v9, s[44:47], s65 offen offset:3072  lds
  s_add_u32 s65, s65, 68608
  s_add_u32 m0, m0, 4096
  s_sub_u32 s66, s66, 8
  s_cmp_lg_u32 s66, 0
  s_cbranch_scc1 L_qdma
  s_call_b64 s[90:91], L_setup
L_noq:
  s_waitcnt lgkmcnt(0)
  s_add_u32 s36, s6, s56
  s_addc_u32 s37, s7, 0
  s_and_b32 s37, s37, 0xffff
  s_waitcnt vmcnt(20)
  buffer_load_dwordx4 a[128:131], v44, s[36:39], s54 offen offset:0 nt
  buffer_load_dwordx4 a[132:135], v44, s[36:39], s54 offen offset:256 nt
  s_waitcnt vmcnt(20)
  buffer_load_dwordx4 a[136:139], v45, s[36:39], s54 offen offset:0 nt
  buffer_load_dwordx4 a[140:143], v45, s[36:39], s54 offen offset:256 nt
  s_waitcnt vmcnt(20)
  buffer_load_dwordx4 a[144:147], v46, s[36:39], s54 offen offset:0 nt
  buffer_load_dwordx4 a[148:151], v46, s[36:39], s54 offen offset:256 nt
  s_waitcnt vmcnt(20)
  buffer_load_dwordx4 a[152:155], v47, s[36:39], s54 offen offset:0 nt
  buffer_load_dwordx4 a[156:159], v47, s[36:39], s54 offen offset:256 nt
  s_add_u32 s54, s52, 4096
  s_waitcnt vmcnt(20)
  buffer_load_dwordx4 a[160:163], v44, s[36:39], s54 offen offset:0 nt
  buffer_load_dwordx4 a[164:167], v44, s[36:39], s54 offen offset:256 nt
  s_waitcnt vmcnt(20)
  buffer_load_dwordx4 a[168:171], v45, s[36:39], s54 offen offset:0 nt
  buffer_load_dwordx4 a[172:175], v45, s[36:39], s54 offen offset:256 nt
  s_waitcnt vmcnt(20)
  buffer_load_dwordx4 a[176:179], v46, s[36:39], s54 offen offset:0 nt
  buffer_load_dwordx4 a[180:183], v46, s[36:39], s54 offen offset:256 nt
  s_waitcnt vmcnt(20)
  buffer_load_dwordx4 a[184:187], v47, s[36:39], s54 offen offset:0 nt
  buffer_load_dwordx4 a[188:191], v47, s[36:39], s54 offen offset:256 nt
  s_add_u32 s54, s52, 8192
  s_waitcnt vmcnt(20)
  buffer_load_dwordx4 a[192:195], v44, s[36:39], s54 offen offset:0 nt
  buffer_load_dwordx4 a[196:199], v44, s[36:39], s54 offen offset:256 nt
  s_waitcnt vmcnt(20)
  buffer_load_dwordx4 a[200:203], v45, s[36:39], s54 offen offset:0 nt
  buffer_load_dwordx4 a[204:207], v45, s[36:39], s54 offen offset:256 nt
  s_waitcnt vmcnt(20)
  buffer_load_dwordx4 a[208:211], v46, s[36:39], s54 offen offset:0 nt
  buffer_load_dwordx4 a[212:215], v46, s[36:39], s54 offen offset:256 nt
  s_cmp_eq_u32 s67, 1
  s_cbranch_scc1 L_isq
  s_call_b64 s[90:91], L_setup
  s_branch L_qc_ret0
L_setup:
  s_getpc_b64 s[72:73]
L_pc0:
  s_add_u32 s72, s72, L_tab-L_pc0
  s_addc_u32 s73, s73, 0
  s_and_b32 s60, s2, 0xfc
  s_load_dword s55, s[72:73], s60
  s_load_dword s50, s[28:29], 0
  s_load_dword s51, s[28:29], 128
  s_lshr_b32 s60, s2, 3
  s_bfe_u32 s61, s2, 0x10002
  s_sub_u32 s62, s60, 14
  s_cmp_ge_u32 s60, 14
  s_cselect_b32 s62, s62, s60
  s_cselect_b32 s63, 1, 0
  s_and_b32 s31, s62, 1
  s_lshr_b32 s35, s62, 1
  s_lshl_b32 s64, s61, 1
  s_add_u32 s30, s64, s63
  s_cmp_lt_u32 s60, 28
  s_cselect_b32 s34, 1, 0
  s_bitcmp1_b32 s2, 1
  s_cbranch_scc0 L_r01a
  s_and_b32 s65, s2, 1
  s_add_u32 s64, s64, s65
  s_add_u32 s30, s64, 4
  s_cmp_eq_u32 s63, 0
  s_cbranch_scc1 L_rda
  s_lshl_b32 s30, s64, 1
  s_bfe_u32 s65, s62, 0x10003
  s_add_u32 s30, s30, s65
  s_and_b32 s35, s62, 7
  s_cmp_lt_u32 s60, 30
  s_cselect_b32 s34, 3, 0
  s_branch L_rda
L_r01a:
  s_bitcmp1_b32 s2, 0
  s_cbranch_scc1 L_rda
  s_lshl_b32 s34, s34, 1
  s_mov_b32 s31, s61
  s_mov_b32 s35, s60
L_rda:
  s_lshl_b32 s33, s31, 3
  s_or_b32 s33, s33, s30
  v_bfe_u32 v3, v0, 0, 1
  v_lshlrev_b32 v124, 12, v3
  v_bfe_u32 v3, v0, 1, 1
  v_lshl_add_u32 v124, v3, 13, v124
  v_bfe_u32 v3, v0, 2, 1
  v_lshl_add_u32 v124, v3, 16, v124
  v_bfe_u32 v3, v0, 3, 1
  v_lshl_add_u32 v124, v3, 14, v124
  v_bfe_u32 v3, v0, 4, 1
  v_lshl_add_u32 v124, v3, 17, v124
  v_bfe_u32 v3, v0, 5, 1
  v_lshl_add_u32 v124, v3, 18, v124
  s_add_u32 s53, s52, 524288
  s_mov_b32 s74, s52
  s_mov_b32 s89, 8
  v_and_b32 v21, 1, v60
  v_mov_b32 v22, 0xffff
  v_lshlrev_b32 v23, 4, v21
  v_lshlrev_b32 v22, v23, v22
  v_bfe_u32 v21, v60, 1, 2
  v_cmp_eq_u32 vcc, 0, v21
  s_nop 1
  v_cndmask_b32 v4, 0, v22, vcc
  v_cmp_eq_u32 vcc, 1, v21
  s_nop 1
  v_cndmask_b32 v5, 0, v22, vcc
  v_cmp_eq_u32 vcc, 2, v21
  s_nop 1
  v_cndmask_b32 v6, 0, v22, vcc
  v_cmp_eq_u32 vcc, 3, v21
  s_nop 1
  v_cndmask_b32 v7, 0, v22, vcc
  v_mov_b32 v58, 0xff7f0000
  v_mov_b32 v57, 0
  v_mov_b32 v32, 0
  v_mov_b32 v33, 0
  v_mov_b32 v34, 0
  v_mov_b32 v35, 0
  v_mov_b32 v36, 0
  v_mov_b32 v37, 0
  v_mov_b32 v38, 0
  v_mov_b32 v39, 0
  s_mov_b32 s57, 0x3db8aa3b
  s_mov_b32 s58, 0
  v_lshrrev_b32 v21, 3, v60
  v_lshl_add_u32 v23, v21, 9, v23
  v_lshl_add_u32 v23, v61, 5, v23
  v_add_u32 v23, 160512, v23
  v_lshl_add_u32 v2, v61, 1, v21
  v_lshlrev_b32 v2, 3, v2
  v_add_u32 v2, 147456, v2
  v_mov_b32 v3, v2
  v_mov_b32 v48, v44
  v_mov_b32 v49, v45
  v_mov_b32 v50, v46
  v_mov_b32 v51, v47
  v_lshlrev_b32 v52, 4, v60
  v_bfe_u32 v21, v61, 0, 1
  v_lshl_add_u32 v52, v21, 9, v52
  v_bfe_u32 v21, v61, 1, 1
  v_lshl_add_u32 v52, v21, 10, v52
  v_add_u32 v53, 2048, v52
  v_add_u32 v54, 32768, v52
  v_add_u32 v55, 34816, v52
  s_add_u32 s40, s8, s56
  s_addc_u32 s41, s9, 0
  s_and_b32 s41, s41, 0xffff
  s_cmp_eq_u32 s34, 3
  s_cselect_b32 s68, 7, 13
  s_cselect_b32 s69, 57344, 0
  v_lshl_add_u32 v125, v0, 4, s69
  s_add_u32 s70, s68, 8
  v_lshl_add_u32 v1, s70, 6, v2
  s_mov_b32 s79, 0
  s_mov_b32 s75, 0
  s_lshl_b32 s77, s76, 8
  s_add_u32 s60, s77, 256
  v_lshl_add_u32 v126, v0, 2, s60
  s_add_u32 s77, s77, 851968
  s_waitcnt lgkmcnt(0)
  s_mul_i32 s50, s50, 0x9e3779b1
  s_mul_i32 s51, s51, 0x9e3779b1
  s_add_u32 s50, s50, 0x7f4a7c15
  s_add_u32 s51, s51, 0x7f4a7c15
  s_cmp_eq_u32 s31, 0
  s_cselect_b32 s59, s50, s51
  s_bitcmp0_b32 s2, 3
  s_cselect_b32 s49, s50, s51
  s_lshl_b32 s60, s2, 3
  s_lshr_b32 s55, s55, s60
  s_and_b32 s55, s55, 0xff
  s_setpc_b64 s[90:91]
L_isq:
  s_call_b64 s[62:63], L_qc
L_qc_ret0:
  global_load_dword v126, v126, s[72:73]
  s_lshl_b32 s60, s76, 11
  s_add_u32 s61, s60, 4096
  v_lshl_add_u32 v83, v0, 4, s61
  v_lshlrev_b32 v84, 3, v0
  v_add_u32 v84, 160512, v84
  s_lshl_b32 s61, s32, 7
  s_add_u32 s60, s60, s61
  s_add_u32 s60, s60, 589824
  v_lshl_add_u32 v81, v0, 1, s60
  s_lshl_b32 s60, s76, 15
  s_lshl_b32 s61, s32, 9
  s_add_u32 s60, s60, s61
  s_add_u32 s60, s60, 65536
  v_lshrrev_b32 v80, 1, v61
  v_lshl_add_u32 v80, v80, 14, s60
  v_lshl_add_u32 v80, v60, 5, v80
  v_and_b32 v21, 1, v61
  v_lshl_add_u32 v80, v21, 4, v80
  v_add_u32 v82, 8192, v80
  s_mov_b64 s[42:43], s[36:37]
  s_sub_u32 s72, s55, s70
  s_sub_u32 s73, s72, 3
  s_waitcnt vmcnt(20)
  buffer_load_dwordx4 a[216:219], v47, s[36:39], s54 offen offset:0 nt
  buffer_load_dwordx4 a[220:223], v47, s[36:39], s54 offen offset:256 nt
  s_add_u32 s54, s52, 12288
  s_waitcnt vmcnt(20)
  buffer_load_dwordx4 a[224:227], v44, s[36:39], s54 offen offset:0 nt
  buffer_load_dwordx4 a[228:231], v44, s[36:39], s54 offen offset:256 nt
  s_waitcnt vmcnt(20)
  buffer_load_dwordx4 a[232:235], v45, s[36:39], s54 offen offset:0 nt
  buffer_load_dwordx4 a[236:239], v45, s[36:39], s54 offen offset:256 nt
  s_waitcnt vmcnt(20)
  buffer_load_dwordx4 a[240:243], v46, s[36:39], s54 offen offset:0 nt
  buffer_load_dwordx4 a[244:247], v46, s[36:39], s54 offen offset:256 nt
  s_waitcnt vmcnt(20)
  buffer_load_dwordx4 a[248:251], v47, s[36:39], s54 offen offset:0 nt
  buffer_load_dwordx4 a[252:255], v47, s[36:39], s54 offen offset:256 nt
  s_add_u32 s54, s52, 65536
  s_waitcnt vmcnt(20)
  buffer_load_dwordx4 v[128:131], v44, s[36:39], s54 offen offset:0 nt
  buffer_load_dwordx4 v[132:135], v44, s[36:39], s54 offen offset:256 nt
  s_waitcnt vmcnt(20)
  buffer_load_dwordx4 v[136:139], v45, s[36:39], s54 offen offset:0 nt
  buffer_load_dwordx4 v[140:143], v45, s[36:39], s54 offen offset:256 nt
  s_waitcnt vmcnt(20)
  buffer_load_dwordx4 v[144:147], v46, s[36:39], s54 offen offset:0 nt
  buffer_load_dwordx4 v[148:151], v46, s[36:39], s54 offen offset:256 nt
  s_waitcnt vmcnt(20)
  buffer_load_dwordx4 v[152:155], v47, s[36:39], s54 offen offset:0 nt
  buffer_load_dwordx4 v[156:159], v47, s[36:39], s54 offen offset:256 nt
  s_add_u32 s54, s52, 69632
  s_waitcnt vmcnt(20)
  buffer_load_dwordx4 v[160:163], v44, s[36:39], s54 offen offset:0 nt
  buffer_load_dwordx4 v[164:167], v44, s[36:39], s54 offen offset:256 nt
  s_waitcnt vmcnt(20)
  buffer_load_dwordx4 v[168:171], v45, s[36:39], s54 offen offset:0 nt
  buffer_load_dwordx4 v[172:175], v45, s[36:39], s54 offen offset:256 nt
  s_waitcnt vmcnt(20)
  buffer_load_dwordx4 v[176:179], v46, s[36:39], s54 offen offset:0 nt
  buffer_load_dwordx4 v[180:183], v46, s[36:39], s54 offen offset:256 nt
  s_waitcnt vmcnt(20)
  buffer_load_dwordx4 v[184:187], v47, s[36:39], s54 offen offset:0 nt
  buffer_load_dwordx4 v[188:191], v47, s[36:39], s54 offen offset:256 nt
  s_add_u32 s54, s52, 73728
  s_waitcnt vmcnt(20)
  buffer_load_dwordx4 v[192:195], v44, s[36:39], s54 offen offset:0 nt
  buffer_load_dwordx4 v[196:199], v44, s[36:39], s54 offen offset:256 nt
  s_waitcnt vmcnt(20)
  buffer_load_dwordx4 v[200:203], v45, s[36:39], s54 offen offset:0 nt
  buffer_load_dwordx4 v[204:207], v45, s[36:39], s54 offen offset:256 nt
  s_waitcnt vmcnt(20)
  buffer_load_dwordx4 v[208:211], v46, s[36:39], s54 offen offset:0 nt
  buffer_load_dwordx4 v[212:215], v46, s[36:39], s54 offen offset:256 nt
  s_waitcnt vmcnt(20)
  buffer_load_dwordx4 v[216:219], v47, s[36:39], s54 offen offset:0 nt
  buffer_load_dwordx4 v[220:223], v47, s[36:39], s54 offen offset:256 nt
  s_add_u32 s54, s52, 77824
  s_waitcnt vmcnt(20)
  buffer_load_dwordx4 v[224:227], v44, s[36:39], s54 offen offset:0 nt
  buffer_load_dwordx4 v[228:231], v44, s[36:39], s54 offen offset:256 nt
  s_waitcnt vmcnt(20)
  buffer_load_dwordx4 v[232:235], v45, s[36:39], s54 offen offset:0 nt
  buffer_load_dwordx4 v[236:239], v45, s[36:39], s54 offen offset:256 nt
  s_waitcnt vmcnt(20)
  buffer_load_dwordx4 v[240:243], v46, s[36:39], s54 offen offset:0 nt
  buffer_load_dwordx4 v[244:247], v46, s[36:39], s54 offen offset:256 nt
  s_waitcnt vmcnt(20)
  buffer_load_dwordx4 v[248:251], v47, s[36:39], s54 offen offset:0 nt
  buffer_load_dwordx4 v[252:255], v47, s[36:39], s54 offen offset:256 nt
  s_add_u32 s54, s52, 16384
L_pfl:
  s_add_u32 m0, s69, 0
  s_waitcnt vmcnt(20)
  buffer_load_dwordx4 v44, s[36:39], s54 offen offset:0 nt lds
  s_add_u32 m0, s69, 768
  s_nop 0
  buffer_load_dwordx4 v44, s[36:39], s54 offen offset:256 nt lds
  s_add_u32 m0, s69, 2048
  s_waitcnt vmcnt(20)
  buffer_load_dwordx4 v45, s[36:39], s54 offen offset:0 nt lds
  s_add_u32 m0, s69, 2816
  s_nop 0
  buffer_load_dwordx4 v45, s[36:39], s54 offen offset:256 nt lds
  s_add_u32 m0, s69, 4096
  s_waitcnt vmcnt(20)
  buffer_load_dwordx4 v46, s[36:39], s54 offen offset:0 nt lds
  s_add_u32 m0, s69, 4864
  s_nop 0
  buffer_load_dwordx4 v46, s[36:39], s54 offen offset:256 nt lds
  s_add_u32 m0, s69, 6144
  s_waitcnt vmcnt(20)
  buffer_load_dwordx4 v47, s[36:39], s54 offen offset:0 nt lds
  s_add_u32 m0, s69, 6912
  s_nop 0
  buffer_load_dwordx4 v47, s[36:39], s54 offen offset:256 nt lds
  s_add_u32 s89, s89, 1
  v_readlane_b32 s54, v124, s89
  s_bitcmp1_b32 s89, 6
  s_cselect_b32 s60, s53, s52
  s_add_u32 s54, s54, s60
  s_add_u32 s69, s69, 0x2000
  s_sub_u32 s68, s68, 1
  s_cmp_lg_u32 s68, 0
  s_cbranch_scc1 L_pfl
  global_load_dwordx4 v[88:91], v83, s[28:29] sc1
  global_load_dwordx4 v[92:95], v83, s[28:29] offset:1024 sc1
  s_waitcnt vmcnt(20)
  buffer_load_dwordx4 a[0:3], v44, s[36:39], s54 offen offset:0 nt
  buffer_load_dwordx4 a[4:7], v44, s[36:39], s54 offen offset:256 nt
  s_waitcnt vmcnt(20)
  buffer_load_dwordx4 a[8:11], v45, s[36:39], s54 offen offset:0 nt
  buffer_load_dwordx4 a[12:15], v45, s[36:39], s54 offen offset:256 nt
  s_waitcnt vmcnt(20)
  buffer_load_dwordx4 a[16:19], v46, s[36:39], s54 offen offset:0 nt
  buffer_load_dwordx4 a[20:23], v46, s[36:39], s54 offen offset:256 nt
  s_waitcnt vmcnt(20)
  buffer_load_dwordx4 a[24:27], v47, s[36:39], s54 offen offset:0 nt
  buffer_load_dwordx4 a[28:31], v47, s[36:39], s54 offen offset:256 nt
  s_add_u32 s89, s89, 1
  v_readlane_b32 s54, v124, s89
  s_bitcmp1_b32 s89, 6
  s_cselect_b32 s60, s53, s52
  s_add_u32 s54, s54, s60
  s_waitcnt vmcnt(20)
  s_nop 0
  buffer_load_dwordx4 a[32:35], v44, s[36:39], s54 offen offset:0 nt
  buffer_load_dwordx4 a[36:39], v44, s[36:39], s54 offen offset:256 nt
  s_waitcnt vmcnt(20)
  buffer_load_dwordx4 a[40:43], v45, s[36:39], s54 offen offset:0 nt
  buffer_load_dwordx4 a[44:47], v45, s[36:39], s54 offen offset:256 nt
  s_waitcnt vmcnt(20)
  buffer_load_dwordx4 a[48:51], v46, s[36:39], s54 offen offset:0 nt
  buffer_load_dwordx4 a[52:55], v46, s[36:39], s54 offen offset:256 nt
  s_waitcnt vmcnt(20)
  buffer_load_dwordx4 a[56:59], v47, s[36:39], s54 offen offset:0 nt
  buffer_load_dwordx4 a[60:63], v47, s[36:39], s54 offen offset:256 nt
  s_add_u32 s89, s89, 1
  v_readlane_b32 s54, v124, s89
  s_bitcmp1_b32 s89, 6
  s_cselect_b32 s60, s53, s52
  s_add_u32 s54, s54, s60
  s_waitcnt vmcnt(20)
  s_nop 0
  buffer_load_dwordx4 a[64:67], v44, s[36:39], s54 offen offset:0 nt
  buffer_load_dwordx4 a[68:71], v44, s[36:39], s54 offen offset:256 nt
  s_waitcnt vmcnt(20)
  buffer_load_dwordx4 a[72:75], v45, s[36:39], s54 offen offset:0 nt
  buffer_load_dwordx4 a[76:79], v45, s[36:39], s54 offen offset:256 nt
  s_waitcnt vmcnt(20)
  buffer_load_dwordx4 a[80:83], v46, s[36:39], s54 offen offset:0 nt
  buffer_load_dwordx4 a[84:87], v46, s[36:39], s54 offen offset:256 nt
  s_waitcnt vmcnt(20)
  buffer_load_dwordx4 a[88:91], v47, s[36:39], s54 offen offset:0 nt
  buffer_load_dwordx4 a[92:95], v47, s[36:39], s54 offen offset:256 nt
  s_add_u32 s89, s89, 1
  v_readlane_b32 s54, v124, s89
  s_bitcmp1_b32 s89, 6
  s_cselect_b32 s60, s53, s52
  s_add_u32 s54, s54, s60
  s_waitcnt vmcnt(24)
  s_mov_b32 s66, 524288
  s_branch L_qchk
L_qpoll:
  global_load_dwordx4 v[88:91], v83, s[28:29] sc1
  global_load_dwordx4 v[92:95], v83, s[28:29] offset:1024 sc1
  s_sub_u32 s66, s66, 1
  s_cbranch_scc1 L_qgot
  s_waitcnt vmcnt(0)
L_qchk:
  v_cmp_ne_u32 s[60:61], s49, v89
  v_cmp_ne_u32 s[62:63], s49, v91
  v_cmp_ne_u32 s[64:65], s49, v93
  v_cmp_ne_u32 vcc, s49, v95
  s_or_b64 s[60:61], s[60:61], s[62:63]
  s_or_b64 vcc, vcc, s[64:65]
  s_or_b64 vcc, vcc, s[60:61]
  s_cbranch_scc1 L_qpoll
L_qgot:
  ds_write2_b32 v84, v88, v90 offset0:0 offset1:1
  ds_write2_b32 v84, v92, v94 offset0:128 offset1:129
  s_waitcnt lgkmcnt(0)
  ds_read_b128 v[64:67], v23 offset:0
  ds_read_b128 v[68:71], v23 offset:256
  ds_read_b128 v[72:75], v23 offset:128
  ds_read_b128 v[76:79], v23 offset:384
  s_waitcnt lgkmcnt(0)
  s_branch L_e0
.p2alignl 12, 0xbf810000
L_ca0:
  s_cbranch_execz L_ca_ret
L_e0:
  s_waitcnt vmcnt(21)
  v_mfma_f32_16x16x32_bf16 v[8:11], a[0:3], v[64:67], 0
  buffer_load_dwordx4 a[0:3], v44, s[36:39], s54 offen offset:0 nt
  s_waitcnt vmcnt(22)
  v_mfma_f32_16x16x32_bf16 v[8:11], a[4:7], v[68:71], v[8:11]
  buffer_load_dwordx4 a[4:7], v44, s[36:39], s54 offen offset:256 nt
  s_waitcnt vmcnt(21)
  v_mfma_f32_16x16x32_bf16 v[8:11], a[8:11], v[72:75], v[8:11]
  buffer_load_dwordx4 a[8:11], v45, s[36:39], s54 offen offset:0 nt
  s_waitcnt vmcnt(22)
  v_mfma_f32_16x16x32_bf16 v[8:11], a[12:15], v[76:79], v[8:11]
  buffer_load_dwordx4 a[12:15], v45, s[36:39], s54 offen offset:256 nt
  s_waitcnt vmcnt(21)
  v_mfma_f32_16x16x32_bf16 v[12:15], a[16:19], v[64:67], 0
  buffer_load_dwordx4 a[16:19], v46, s[36:39], s54 offen offset:0 nt
  s_waitcnt vmcnt(22)
  v_mfma_f32_16x16x32_bf16 v[12:15], a[20:23], v[68:71], v[12:15]
  buffer_load_dwordx4 a[20:23], v46, s[36:39], s54 offen offset:256 nt
  s_waitcnt vmcnt(21)
  v_mfma_f32_16x16x32_bf16 v[12:15], a[24:27], v[72:75], v[12:15]
  buffer_load_dwordx4 a[24:27], v47, s[36:39], s54 offen offset:0 nt
  s_waitcnt vmcnt(22)
  v_mfma_f32_16x16x32_bf16 v[12:15], a[28:31], v[76:79], v[12:15]
  buffer_load_dwordx4 a[28:31], v47, s[36:39], s54 offen offset:256 nt
  s_add_u32 s89, s89, 1
  v_readlane_b32 s54, v124, s89
  s_bitcmp1_b32 s89, 6
  s_cselect_b32 s60, s53, s52
  s_add_u32 s54, s54, s60
  v_mov_b32_dpp v16, v8 quad_perm:[0,0,2,2] row_mask:0xf bank_mask:0xf
  v_mov_b32_dpp v17, v10 quad_perm:[0,0,2,2] row_mask:0xf bank_mask:0xf
  s_nop 0
  v_add_f32_dpp v16, v9, v16 quad_perm:[1,1,3,3] row_mask:0xf bank_mask:0xf
  v_add_f32_dpp v17, v11, v17 quad_perm:[1,1,3,3] row_mask:0xf bank_mask:0xf
  v_cvt_pk_bf16_f32 v20, v16, v17
  v_max3_f32 v58, v16, v17, v58
  v_mov_b32_dpp v18, v12 quad_perm:[0,0,2,2] row_mask:0xf bank_mask:0xf
  v_mov_b32_dpp v19, v14 quad_perm:[0,0,2,2] row_mask:0xf bank_mask:0xf
  s_nop 0
  v_add_f32_dpp v18, v13, v18 quad_perm:[1,1,3,3] row_mask:0xf bank_mask:0xf
  v_add_f32_dpp v19, v15, v19 quad_perm:[1,1,3,3] row_mask:0xf bank_mask:0xf
  v_cvt_pk_bf16_f32 v21, v18, v19
  v_max3_f32 v58, v18, v19, v58
  ds_write_b64 v1, v[20:21]
  v_add_u32 v1, 64, v1
  s_waitcnt vmcnt(21)
  v_mfma_f32_16x16x32_bf16 v[8:11], a[32:35], v[64:67], 0
  buffer_load_dwordx4 a[32:35], v44, s[36:39], s54 offen offset:0 nt
  s_waitcnt vmcnt(22)
  v_mfma_f32_16x16x32_bf16 v[8:11], a[36:39], v[68:71], v[8:11]
  buffer_load_dwordx4 a[36:39], v44, s[36:39], s54 offen offset:256 nt
  s_waitcnt vmcnt(21)
  v_mfma_f32_16x16x32_bf16 v[8:11], a[40:43], v[72:75], v[8:11]
  buffer_load_dwordx4 a[40:43], v45, s[36:39], s54 offen offset:0 nt
  s_waitcnt vmcnt(22)
  v_mfma_f32_16x16x32_bf16 v[8:11], a[44:47], v[76:79], v[8:11]
  buffer_load_dwordx4 a[44:47], v45, s[36:39], s54 offen offset:256 nt
  s_waitcnt vmcnt(21)
  v_mfma_f32_16x16x32_bf16 v[12:15], a[48:51], v[64:67], 0
  buffer_load_dwordx4 a[48:51], v46, s[36:39], s54 offen offset:0 nt
  s_waitcnt vmcnt(22)
  v_mfma_f32_16x16x32_bf16 v[12:15], a[52:55], v[68:71], v[12:15]
  buffer_load_dwordx4 a[52:55], v46, s[36:39], s54 offen offset:256 nt
  s_waitcnt vmcnt(21)
  v_mfma_f32_16x16x32_bf16 v[12:15], a[56:59], v[72:75], v[12:15]
  buffer_load_dwordx4 a[56:59], v47, s[36:39], s54 offen offset:0 nt
  s_waitcnt vmcnt(22)
  v_mfma_f32_16x16x32_bf16 v[12:15], a[60:63], v[76:79], v[12:15]
  buffer_load_dwordx4 a[60:63], v47, s[36:39], s54 offen offset:256 nt
  s_add_u32 s89, s89, 1
  v_readlane_b32 s54, v124, s89
  s_bitcmp1_b32 s89, 6
  s_cselect_b32 s60, s53, s52
  s_add_u32 s54, s54, s60
  v_mov_b32_dpp v16, v8 quad_perm:[0,0,2,2] row_mask:0xf bank_mask:0xf
  v_mov_b32_dpp v17, v10 quad_perm:[0,0,2,2] row_mask:0xf bank_mask:0xf
  s_nop 0
  v_add_f32_dpp v16, v9, v16 quad_perm:[1,1,3,3] row_mask:0xf bank_mask:0xf
  v_add_f32_dpp v17, v11, v17 quad_perm:[1,1,3,3] row_mask:0xf bank_mask:0xf
  v_cvt_pk_bf16_f32 v20, v16, v17
  v_max3_f32 v58, v16, v17, v58
  v_mov_b32_dpp v18, v12 quad_perm:[0,0,2,2] row_mask:0xf bank_mask:0xf
  v_mov_b32_dpp v19, v14 quad_perm:[0,0,2,2] row_mask:0xf bank_mask:0xf
  s_nop 0
  v_add_f32_dpp v18, v13, v18 quad_perm:[1,1,3,3] row_mask:0xf bank_mask:0xf
  v_add_f32_dpp v19, v15, v19 quad_perm:[1,1,3,3] row_mask:0xf bank_mask:0xf
  v_cvt_pk_bf16_f32 v21, v18, v19
  v_max3_f32 v58, v18, v19, v58
  ds_write_b64 v1, v[20:21]
  v_add_u32 v1, 64, v1
  s_waitcnt vmcnt(21)
  v_mfma_f32_16x16x32_bf16 v[8:11], a[64:67], v[64:67], 0
  buffer_load_dwordx4 a[64:67], v44, s[36:39], s54 offen offset:0 nt
  s_waitcnt vmcnt(22)
  v_mfma_f32_16x16x32_bf16 v[8:11], a[68:71], v[68:71], v[8:11]
  buffer_load_dwordx4 a[68:71], v44, s[36:39], s54 offen offset:256 nt
  s_waitcnt vmcnt(21)
  v_mfma_f32_16x16x32_bf16 v[8:11], a[72:75], v[72:75], v[8:11]
  buffer_load_dwordx4 a[72:75], v45, s[36:39], s54 offen offset:0 nt
  s_waitcnt vmcnt(22)
  v_mfma_f32_16x16x32_bf16 v[8:11], a[76:79], v[76:79], v[8:11]
  buffer_load_dwordx4 a[76:79], v45, s[36:39], s54 offen offset:256 nt
  s_waitcnt vmcnt(21)
  v_mfma_f32_16x16x32_bf16 v[12:15], a[80:83], v[64:67], 0
  buffer_load_dwordx4 a[80:83], v46, s[36:39], s54 offen offset:0 nt
  s_waitcnt vmcnt(22)
  v_mfma_f32_16x16x32_bf16 v[12:15], a[84:87], v[68:71], v[12:15]
  buffer_load_dwordx4 a[84:87], v46, s[36:39], s54 offen offset:256 nt
  s_waitcnt vmcnt(21)
  v_mfma_f32_16x16x32_bf16 v[12:15], a[88:91], v[72:75], v[12:15]
  buffer_load_dwordx4 a[88:91], v47, s[36:39], s54 offen offset:0 nt
  s_waitcnt vmcnt(22)
  v_mfma_f32_16x16x32_bf16 v[12:15], a[92:95], v[76:79], v[12:15]
  buffer_load_dwordx4 a[92:95], v47, s[36:39], s54 offen offset:256 nt
  s_add_u32 s89, s89, 1
  v_readlane_b32 s54, v124, s89
  s_bitcmp1_b32 s89, 6
  s_cselect_b32 s60, s53, s52
  s_add_u32 s54, s54, s60
  v_mov_b32_dpp v16, v8 quad_perm:[0,0,2,2] row_mask:0xf bank_mask:0xf
  v_mov_b32_dpp v17, v10 quad_perm:[0,0,2,2] row_mask:0xf bank_mask:0xf
  s_nop 0
  v_add_f32_dpp v16, v9, v16 quad_perm:[1,1,3,3] row_mask:0xf bank_mask:0xf
  v_add_f32_dpp v17, v11, v17 quad_perm:[1,1,3,3] row_mask:0xf bank_mask:0xf
  v_cvt_pk_bf16_f32 v20, v16, v17
  v_max3_f32 v58, v16, v17, v58
  v_mov_b32_dpp v18, v12 quad_perm:[0,0,2,2] row_mask:0xf bank_mask:0xf
  v_mov_b32_dpp v19, v14 quad_perm:[0,0,2,2] row_mask:0xf bank_mask:0xf
  s_nop 0
  v_add_f32_dpp v18, v13, v18 quad_perm:[1,1,3,3] row_mask:0xf bank_mask:0xf
  v_add_f32_dpp v19, v15, v19 quad_perm:[1,1,3,3] row_mask:0xf bank_mask:0xf
  v_cvt_pk_bf16_f32 v21, v18, v19
  v_max3_f32 v58, v18, v19, v58
  ds_write_b64 v1, v[20:21]
  v_add_u32 v1, 64, v1
  s_sub_u32 s72, s72, 3
  s_sub_u32 s73, s73, 3
  s_add_u32 s58, s58, 1
  s_cmp_eq_u32 s58, 1
  s_cbranch_scc1 L_x0
  s_cmp_eq_u32 s58, 2
  s_cbranch_scc1 L_x1
  s_cmp_eq_u32 s58, 3
  s_cbranch_scc1 L_x2
  s_cmp_eq_u32 s58, 4
  s_cbranch_scc1 L_x3
  s_cmp_eq_u32 s58, 5
  s_cbranch_scc1 L_x4
  s_cmp_eq_u32 s58, 6
  s_cbranch_scc1 L_x5
  s_cmp_eq_u32 s58, 7
  s_cbranch_scc1 L_x6
  s_cmp_eq_u32 s58, 8
  s_cbranch_scc1 L_x7
  s_branch L_xs
L_ca1:
  s_cbranch_execz L_ca0
L_k0:
  s_sub_u32 s73, s73, 1
  s_cbranch_scc1 L_ls_k0
L_lb_k0:
  s_waitcnt vmcnt(20)
  v_mfma_f32_16x16x32_bf16 v[8:11], a[0:3], v[64:67], 0
  buffer_load_dwordx4 a[0:3], v44, s[36:39], s54 offen offset:0 nt
  s_waitcnt vmcnt(20)
  v_mfma_f32_16x16x32_bf16 v[8:11], a[4:7], v[68:71], v[8:11]
  buffer_load_dwordx4 a[4:7], v44, s[36:39], s54 offen offset:256 nt
  s_waitcnt vmcnt(20)
  v_mfma_f32_16x16x32_bf16 v[8:11], a[8:11], v[72:75], v[8:11]
  buffer_load_dwordx4 a[8:11], v45, s[36:39], s54 offen offset:0 nt
  s_waitcnt vmcnt(20)
  v_mfma_f32_16x16x32_bf16 v[8:11], a[12:15], v[76:79], v[8:11]
  buffer_load_dwordx4 a[12:15], v45, s[36:39], s54 offen offset:256 nt
  s_waitcnt vmcnt(20)
  v_mfma_f32_16x16x32_bf16 v[12:15], a[16:19], v[64:67], 0
  buffer_load_dwordx4 a[16:19], v46, s[36:39], s54 offen offset:0 nt
  s_waitcnt vmcnt(20)
  v_mfma_f32_16x16x32_bf16 v[12:15], a[20:23], v[68:71], v[12:15]
  buffer_load_dwordx4 a[20:23], v46, s[36:39], s54 offen offset:256 nt
  s_waitcnt vmcnt(20)
  v_mfma_f32_16x16x32_bf16 v[12:15], a[24:27], v[72:75], v[12:15]
  buffer_load_dwordx4 a[24:27], v47, s[36:39], s54 offen offset:0 nt
  s_waitcnt vmcnt(20)
  v_mfma_f32_16x16x32_bf16 v[12:15], a[28:31], v[76:79], v[12:15]
  buffer_load_dwordx4 a[28:31], v47, s[36:39], s54 offen offset:256 nt
  s_add_u32 s89, s89, 1
  v_readlane_b32 s54, v124, s89
  s_bitcmp1_b32 s89, 6
  s_cselect_b32 s60, s53, s52
  s_add_u32 s54, s54, s60
  v_mov_b32_dpp v16, v8 quad_perm:[0,0,2,2] row_mask:0xf bank_mask:0xf
  v_mov_b32_dpp v17, v10 quad_perm:[0,0,2,2] row_mask:0xf bank_mask:0xf
  s_nop 0
  v_add_f32_dpp v16, v9, v16 quad_perm:[1,1,3,3] row_mask:0xf bank_mask:0xf
  v_add_f32_dpp v17, v11, v17 quad_perm:[1,1,3,3] row_mask:0xf bank_mask:0xf
  v_cvt_pk_bf16_f32 v20, v16, v17
  v_max3_f32 v58, v16, v17, v58
  v_mov_b32_dpp v18, v12 quad_perm:[0,0,2,2] row_mask:0xf bank_mask:0xf
  v_mov_b32_dpp v19, v14 quad_perm:[0,0,2,2] row_mask:0xf bank_mask:0xf
  s_nop 0
  v_add_f32_dpp v18, v13, v18 quad_perm:[1,1,3,3] row_mask:0xf bank_mask:0xf
  v_add_f32_dpp v19, v15, v19 quad_perm:[1,1,3,3] row_mask:0xf bank_mask:0xf
  v_cvt_pk_bf16_f32 v21, v18, v19
  v_max3_f32 v58, v18, v19, v58
  ds_write_b64 v1, v[20:21]
  v_add_u32 v1, 64, v1
  s_sub_u32 s72, s72, 1
  s_cmp_eq_u32 s72, 0
  s_cbranch_scc1 L_mid1
L_k1:
  s_sub_u32 s73, s73, 1
  s_cbranch_scc1 L_ls_k1
L_lb_k1:
  s_waitcnt vmcnt(20)
  v_mfma_f32_16x16x32_bf16 v[8:11], a[32:35], v[64:67], 0
  buffer_load_dwordx4 a[32:35], v44, s[36:39], s54 offen offset:0 nt
  s_waitcnt vmcnt(20)
  v_mfma_f32_16x16x32_bf16 v[8:11], a[36:39], v[68:71], v[8:11]
  buffer_load_dwordx4 a[36:39], v44, s[36:39], s54 offen offset:256 nt
  s_waitcnt vmcnt(20)
  v_mfma_f32_16x16x32_bf16 v[8:11], a[40:43], v[72:75], v[8:11]
  buffer_load_dwordx4 a[40:43], v45, s[36:39], s54 offen offset:0 nt
  s_waitcnt vmcnt(20)
  v_mfma_f32_16x16x32_bf16 v[8:11], a[44:47], v[76:79], v[8:11]
  buffer_load_dwordx4 a[44:47], v45, s[36:39], s54 offen offset:256 nt
  s_waitcnt vmcnt(20)
  v_mfma_f32_16x16x32_bf16 v[12:15], a[48:51], v[64:67], 0
  buffer_load_dwordx4 a[48:51], v46, s[36:39], s54 offen offset:0 nt
  s_waitcnt vmcnt(20)
  v_mfma_f32_16x16x32_bf16 v[12:15], a[52:55], v[68:71], v[12:15]
  buffer_load_dwordx4 a[52:55], v46, s[36:39], s54 offen offset:256 nt
  s_waitcnt vmcnt(20)
  v_mfma_f32_16x16x32_bf16 v[12:15], a[56:59], v[72:75], v[12:15]
  buffer_load_dwordx4 a[56:59], v47, s[36:39], s54 offen offset:0 nt
  s_waitcnt vmcnt(20)
  v_mfma_f32_16x16x32_bf16 v[12:15], a[60:63], v[76:79], v[12:15]
  buffer_load_dwordx4 a[60:63], v47, s[36:39], s54 offen offset:256 nt
  s_add_u32 s89, s89, 1
  v_readlane_b32 s54, v124, s89
  s_bitcmp1_b32 s89, 6
  s_cselect_b32 s60, s53, s52
  s_add_u32 s54, s54, s60
  v_mov_b32_dpp v16, v8 quad_perm:[0,0,2,2] row_mask:0xf bank_mask:0xf
  v_mov_b32_dpp v17, v10 quad_perm:[0,0,2,2] row_mask:0xf bank_mask:0xf
  s_nop 0
  v_add_f32_dpp v16, v9, v16 quad_perm:[1,1,3,3] row_mask:0xf bank_mask:0xf
  v_add_f32_dpp v17, v11, v17 quad_perm:[1,1,3,3] row_mask:0xf bank_mask:0xf
  v_cvt_pk_bf16_f32 v20, v16, v17
  v_max3_f32 v58, v16, v17, v58
  v_mov_b32_dpp v18, v12 quad_perm:[0,0,2,2] row_mask:0xf bank_mask:0xf
  v_mov_b32_dpp v19, v14 quad_perm:[0,0,2,2] row_mask:0xf bank_mask:0xf
  s_nop 0
  v_add_f32_dpp v18, v13, v18 quad_perm:[1,1,3,3] row_mask:0xf bank_mask:0xf
  v_add_f32_dpp v19, v15, v19 quad_perm:[1,1,3,3] row_mask:0xf bank_mask:0xf
  v_cvt_pk_bf16_f32 v21, v18, v19
  v_max3_f32 v58, v18, v19, v58
  ds_write_b64 v1, v[20:21]
  v_add_u32 v1, 64, v1
  s_sub_u32 s72, s72, 1
  s_cmp_eq_u32 s72, 0
  s_cbranch_scc1 L_mid2
L_k2:
  s_sub_u32 s73, s73, 1
  s_cbranch_scc1 L_ls_k2
L_lb_k2:
  s_waitcnt vmcnt(20)
  v_mfma_f32_16x16x32_bf16 v[8:11], a[64:67], v[64:67], 0
  buffer_load_dwordx4 a[64:67], v44, s[36:39], s54 offen offset:0 nt
  s_waitcnt vmcnt(20)
  v_mfma_f32_16x16x32_bf16 v[8:11], a[68:71], v[68:71], v[8:11]
  buffer_load_dwordx4 a[68:71], v44, s[36:39], s54 offen offset:256 nt
  s_waitcnt vmcnt(20)
  v_mfma_f32_16x16x32_bf16 v[8:11], a[72:75], v[72:75], v[8:11]
  buffer_load_dwordx4 a[72:75], v45, s[36:39], s54 offen offset:0 nt
  s_waitcnt vmcnt(20)
  v_mfma_f32_16x16x32_bf16 v[8:11], a[76:79], v[76:79], v[8:11]
  buffer_load_dwordx4 a[76:79], v45, s[36:39], s54 offen offset:256 nt
  s_waitcnt vmcnt(20)
  v_mfma_f32_16x16x32_bf16 v[12:15], a[80:83], v[64:67], 0
  buffer_load_dwordx4 a[80:83], v46, s[36:39], s54 offen offset:0 nt
  s_waitcnt vmcnt(20)
  v_mfma_f32_16x16x32_bf16 v[12:15], a[84:87], v[68:71], v[12:15]
  buffer_load_dwordx4 a[84:87], v46, s[36:39], s54 offen offset:256 nt
  s_waitcnt vmcnt(20)
  v_mfma_f32_16x16x32_bf16 v[12:15], a[88:91], v[72:75], v[12:15]
  buffer_load_dwordx4 a[88:91], v47, s[36:39], s54 offen offset:0 nt
  s_waitcnt vmcnt(20)
  v_mfma_f32_16x16x32_bf16 v[12:15], a[92:95], v[76:79], v[12:15]
  buffer_load_dwordx4 a[92:95], v47, s[36:39], s54 offen offset:256 nt
  s_add_u32 s89, s89, 1
  v_readlane_b32 s54, v124, s89
  s_bitcmp1_b32 s89, 6
  s_cselect_b32 s60, s53, s52
  s_add_u32 s54, s54, s60
  v_mov_b32_dpp v16, v8 quad_perm:[0,0,2,2] row_mask:0xf bank_mask:0xf
  v_mov_b32_dpp v17, v10 quad_perm:[0,0,2,2] row_mask:0xf bank_mask:0xf
  s_nop 0
  v_add_f32_dpp v16, v9, v16 quad_perm:[1,1,3,3] row_mask:0xf bank_mask:0xf
  v_add_f32_dpp v17, v11, v17 quad_perm:[1,1,3,3] row_mask:0xf bank_mask:0xf
  v_cvt_pk_bf16_f32 v20, v16, v17
  v_max3_f32 v58, v16, v17, v58
  v_mov_b32_dpp v18, v12 quad_perm:[0,0,2,2] row_mask:0xf bank_mask:0xf
  v_mov_b32_dpp v19, v14 quad_perm:[0,0,2,2] row_mask:0xf bank_mask:0xf
  s_nop 0
  v_add_f32_dpp v18, v13, v18 quad_perm:[1,1,3,3] row_mask:0xf bank_mask:0xf
  v_add_f32_dpp v19, v15, v19 quad_perm:[1,1,3,3] row_mask:0xf bank_mask:0xf
  v_cvt_pk_bf16_f32 v21, v18, v19
  v_max3_f32 v58, v18, v19, v58
  ds_write_b64 v1, v[20:21]
  v_add_u32 v1, 64, v1
  s_sub_u32 s72, s72, 1
  s_cmp_eq_u32 s72, 0
  s_cbranch_scc1 L_mid0
  s_branch L_k0
L_ca_end:
.p2alignl 12, 0xbf810000
L_cx0:
  s_cbranch_execz L_cx_ret
L_x0:
  v_mfma_f32_16x16x32_bf16 v[8:11], a[128:131], v[64:67], 0
  v_mfma_f32_16x16x32_bf16 v[8:11], a[132:135], v[68:71], v[8:11]
  v_mfma_f32_16x16x32_bf16 v[8:11], a[136:139], v[72:75], v[8:11]
  v_mfma_f32_16x16x32_bf16 v[8:11], a[140:143], v[76:79], v[8:11]
  v_mfma_f32_16x16x32_bf16 v[12:15], a[144:147], v[64:67], 0
  v_mfma_f32_16x16x32_bf16 v[12:15], a[148:151], v[68:71], v[12:15]
  v_mfma_f32_16x16x32_bf16 v[12:15], a[152:155], v[72:75], v[12:15]
  v_mfma_f32_16x16x32_bf16 v[12:15], a[156:159], v[76:79], v[12:15]
  s_nop 3
  v_mov_b32_dpp v16, v8 quad_perm:[0,0,2,2] row_mask:0xf bank_mask:0xf
  v_mov_b32_dpp v17, v10 quad_perm:[0,0,2,2] row_mask:0xf bank_mask:0xf
  s_nop 0
  v_add_f32_dpp v16, v9, v16 quad_perm:[1,1,3,3] row_mask:0xf bank_mask:0xf
  v_add_f32_dpp v17, v11, v17 quad_perm:[1,1,3,3] row_mask:0xf bank_mask:0xf
  v_cvt_pk_bf16_f32 v20, v16, v17
  v_max3_f32 v58, v16, v17, v58
  v_mov_b32_dpp v18, v12 quad_perm:[0,0,2,2] row_mask:0xf bank_mask:0xf
  v_mov_b32_dpp v19, v14 quad_perm:[0,0,2,2] row_mask:0xf bank_mask:0xf
  s_nop 0
  v_add_f32_dpp v18, v13, v18 quad_perm:[1,1,3,3] row_mask:0xf bank_mask:0xf
  v_add_f32_dpp v19, v15, v19 quad_perm:[1,1,3,3] row_mask:0xf bank_mask:0xf
  v_cvt_pk_bf16_f32 v21, v18, v19
  v_max3_f32 v58, v18, v19, v58
  ds_write_b64 v2, v[20:21]
  v_add_u32 v2, 64, v2
  s_branch L_e0
L_x1:
  v_mfma_f32_16x16x32_bf16 v[8:11], a[160:163], v[64:67], 0
  v_mfma_f32_16x16x32_bf16 v[8:11], a[164:167], v[68:71], v[8:11]
  v_mfma_f32_16x16x32_bf16 v[8:11], a[168:171], v[72:75], v[8:11]
  v_mfma_f32_16x16x32_bf16 v[8:11], a[172:175], v[76:79], v[8:11]
  v_mfma_f32_16x16x32_bf16 v[12:15], a[176:179], v[64:67], 0
  v_mfma_f32_16x16x32_bf16 v[12:15], a[180:183], v[68:71], v[12:15]
  v_mfma_f32_16x16x32_bf16 v[12:15], a[184:187], v[72:75], v[12:15]
  v_mfma_f32_16x16x32_bf16 v[12:15], a[188:191], v[76:79], v[12:15]
  s_nop 3
  v_mov_b32_dpp v16, v8 quad_perm:[0,0,2,2] row_mask:0xf bank_mask:0xf
  v_mov_b32_dpp v17, v10 quad_perm:[0,0,2,2] row_mask:0xf bank_mask:0xf
  s_nop 0
  v_add_f32_dpp v16, v9, v16 quad_perm:[1,1,3,3] row_mask:0xf bank_mask:0xf
  v_add_f32_dpp v17, v11, v17 quad_perm:[1,1,3,3] row_mask:0xf bank_mask:0xf
  v_cvt_pk_bf16_f32 v20, v16, v17
  v_max3_f32 v58, v16, v17, v58
  v_mov_b32_dpp v18, v12 quad_perm:[0,0,2,2] row_mask:0xf bank_mask:0xf
  v_mov_b32_dpp v19, v14 quad_perm:[0,0,2,2] row_mask:0xf bank_mask:0xf
  s_nop 0
  v_add_f32_dpp v18, v13, v18 quad_perm:[1,1,3,3] row_mask:0xf bank_mask:0xf
  v_add_f32_dpp v19, v15, v19 quad_perm:[1,1,3,3] row_mask:0xf bank_mask:0xf
  v_cvt_pk_bf16_f32 v21, v18, v19
  v_max3_f32 v58, v18, v19, v58
  ds_write_b64 v2, v[20:21]
  v_add_u32 v2, 64, v2
  s_branch L_e0
L_x2:
  v_mfma_f32_16x16x32_bf16 v[8:11], a[192:195], v[64:67], 0
  v_mfma_f32_16x16x32_bf16 v[8:11], a[196:199], v[68:71], v[8:11]
  v_mfma_f32_16x16x32_bf16 v[8:11], a[200:203], v[72:75], v[8:11]
  v_mfma_f32_16x16x32_bf16 v[8:11], a[204:207], v[76:79], v[8:11]
  v_mfma_f32_16x16x32_bf16 v[12:15], a[208:211], v[64:67], 0
  v_mfma_f32_16x16x32_bf16 v[12:15], a[212:215], v[68:71], v[12:15]
  v_mfma_f32_16x16x32_bf16 v[12:15], a[216:219], v[72:75], v[12:15]
  v_mfma_f32_16x16x32_bf16 v[12:15], a[220:223], v[76:79], v[12:15]
  s_nop 3
  v_mov_b32_dpp v16, v8 quad_perm:[0,0,2,2] row_mask:0xf bank_mask:0xf
  v_mov_b32_dpp v17, v10 quad_perm:[0,0,2,2] row_mask:0xf bank_mask:0xf
  s_nop 0
  v_add_f32_dpp v16, v9, v16 quad_perm:[1,1,3,3] row_mask:0xf bank_mask:0xf
  v_add_f32_dpp v17, v11, v17 quad_perm:[1,1,3,3] row_mask:0xf bank_mask:0xf
  v_cvt_pk_bf16_f32 v20, v16, v17
  v_max3_f32 v58, v16, v17, v58
  v_mov_b32_dpp v18, v12 quad_perm:[0,0,2,2] row_mask:0xf bank_mask:0xf
  v_mov_b32_dpp v19, v14 quad_perm:[0,0,2,2] row_mask:0xf bank_mask:0xf
  s_nop 0
  v_add_f32_dpp v18, v13, v18 quad_perm:[1,1,3,3] row_mask:0xf bank_mask:0xf
  v_add_f32_dpp v19, v15, v19 quad_perm:[1,1,3,3] row_mask:0xf bank_mask:0xf
  v_cvt_pk_bf16_f32 v21, v18, v19
  v_max3_f32 v58, v18, v19, v58
  ds_write_b64 v2, v[20:21]
  v_add_u32 v2, 64, v2
  s_branch L_e0
L_x3:
  v_mfma_f32_16x16x32_bf16 v[8:11], a[224:227], v[64:67], 0
  v_mfma_f32_16x16x32_bf16 v[8:11], a[228:231], v[68:71], v[8:11]
  v_mfma_f32_16x16x32_bf16 v[8:11], a[232:235], v[72:75], v[8:11]
  v_mfma_f32_16x16x32_bf16 v[8:11], a[236:239], v[76:79], v[8:11]
  v_mfma_f32_16x16x32_bf16 v[12:15], a[240:243], v[64:67], 0
  v_mfma_f32_16x16x32_bf16 v[12:15], a[244:247], v[68:71], v[12:15]
  v_mfma_f32_16x16x32_bf16 v[12:15], a[248:251], v[72:75], v[12:15]
  v_mfma_f32_16x16x32_bf16 v[12:15], a[252:255], v[76:79], v[12:15]
  s_nop 3
  v_mov_b32_dpp v16, v8 quad_perm:[0,0,2,2] row_mask:0xf bank_mask:0xf
  v_mov_b32_dpp v17, v10 quad_perm:[0,0,2,2] row_mask:0xf bank_mask:0xf
  s_nop 0
  v_add_f32_dpp v16, v9, v16 quad_perm:[1,1,3,3] row_mask:0xf bank_mask:0xf
  v_add_f32_dpp v17, v11, v17 quad_perm:[1,1,3,3] row_mask:0xf bank_mask:0xf
  v_cvt_pk_bf16_f32 v20, v16, v17
  v_max3_f32 v58, v16, v17, v58
  v_mov_b32_dpp v18, v12 quad_perm:[0,0,2,2] row_mask:0xf bank_mask:0xf
  v_mov_b32_dpp v19, v14 quad_perm:[0,0,2,2] row_mask:0xf bank_mask:0xf
  s_nop 0
  v_add_f32_dpp v18, v13, v18 quad_perm:[1,1,3,3] row_mask:0xf bank_mask:0xf
  v_add_f32_dpp v19, v15, v19 quad_perm:[1,1,3,3] row_mask:0xf bank_mask:0xf
  v_cvt_pk_bf16_f32 v21, v18, v19
  v_max3_f32 v58, v18, v19, v58
  ds_write_b64 v2, v[20:21]
  v_add_u32 v2, 64, v2
  s_branch L_e0
L_x4:
  v_mfma_f32_16x16x32_bf16 v[8:11], v[128:131], v[64:67], 0
  v_mfma_f32_16x16x32_bf16 v[8:11], v[132:135], v[68:71], v[8:11]
  v_mfma_f32_16x16x32_bf16 v[8:11], v[136:139], v[72:75], v[8:11]
  v_mfma_f32_16x16x32_bf16 v[8:11], v[140:143], v[76:79], v[8:11]
  v_mfma_f32_16x16x32_bf16 v[12:15], v[144:147], v[64:67], 0
  v_mfma_f32_16x16x32_bf16 v[12:15], v[148:151], v[68:71], v[12:15]
  v_mfma_f32_16x16x32_bf16 v[12:15], v[152:155], v[72:75], v[12:15]
  v_mfma_f32_16x16x32_bf16 v[12:15], v[156:159], v[76:79], v[12:15]
  s_nop 3
  v_mov_b32_dpp v16, v8 quad_perm:[0,0,2,2] row_mask:0xf bank_mask:0xf
  v_mov_b32_dpp v17, v10 quad_perm:[0,0,2,2] row_mask:0xf bank_mask:0xf
  s_nop 0
  v_add_f32_dpp v16, v9, v16 quad_perm:[1,1,3,3] row_mask:0xf bank_mask:0xf
  v_add_f32_dpp v17, v11, v17 quad_perm:[1,1,3,3] row_mask:0xf bank_mask:0xf
  v_cvt_pk_bf16_f32 v20, v16, v17
  v_max3_f32 v58, v16, v17, v58
  v_mov_b32_dpp v18, v12 quad_perm:[0,0,2,2] row_mask:0xf bank_mask:0xf
  v_mov_b32_dpp v19, v14 quad_perm:[0,0,2,2] row_mask:0xf bank_mask:0xf
  s_nop 0
  v_add_f32_dpp v18, v13, v18 quad_perm:[1,1,3,3] row_mask:0xf bank_mask:0xf
  v_add_f32_dpp v19, v15, v19 quad_perm:[1,1,3,3] row_mask:0xf bank_mask:0xf
  v_cvt_pk_bf16_f32 v21, v18, v19
  v_max3_f32 v58, v18, v19, v58
  ds_write_b64 v2, v[20:21]
  v_add_u32 v2, 64, v2
  s_branch L_e0
L_cx1:
  s_cbranch_execz L_cx0
L_x5:
  v_mfma_f32_16x16x32_bf16 v[8:11], v[160:163], v[64:67], 0
  v_mfma_f32_16x16x32_bf16 v[8:11], v[164:167], v[68:71], v[8:11]
  v_mfma_f32_16x16x32_bf16 v[8:11], v[168:171], v[72:75], v[8:11]
  v_mfma_f32_16x16x32_bf16 v[8:11], v[172:175], v[76:79], v[8:11]
  v_mfma_f32_16x16x32_bf16 v[12:15], v[176:179], v[64:67], 0
  v_mfma_f32_16x16x32_bf16 v[12:15], v[180:183], v[68:71], v[12:15]
  v_mfma_f32_16x16x32_bf16 v[12:15], v[184:187], v[72:75], v[12:15]
  v_mfma_f32_16x16x32_bf16 v[12:15], v[188:191], v[76:79], v[12:15]
  s_nop 3
  v_mov_b32_dpp v16, v8 quad_perm:[0,0,2,2] row_mask:0xf bank_mask:0xf
  v_mov_b32_dpp v17, v10 quad_perm:[0,0,2,2] row_mask:0xf bank_mask:0xf
  s_nop 0
  v_add_f32_dpp v16, v9, v16 quad_perm:[1,1,3,3] row_mask:0xf bank_mask:0xf
  v_add_f32_dpp v17, v11, v17 quad_perm:[1,1,3,3] row_mask:0xf bank_mask:0xf
  v_cvt_pk_bf16_f32 v20, v16, v17
  v_max3_f32 v58, v16, v17, v58
  v_mov_b32_dpp v18, v12 quad_perm:[0,0,2,2] row_mask:0xf bank_mask:0xf
  v_mov_b32_dpp v19, v14 quad_perm:[0,0,2,2] row_mask:0xf bank_mask:0xf
  s_nop 0
  v_add_f32_dpp v18, v13, v18 quad_perm:[1,1,3,3] row_mask:0xf bank_mask:0xf
  v_add_f32_dpp v19, v15, v19 quad_perm:[1,1,3,3] row_mask:0xf bank_mask:0xf
  v_cvt_pk_bf16_f32 v21, v18, v19
  v_max3_f32 v58, v18, v19, v58
  ds_write_b64 v2, v[20:21]
  v_add_u32 v2, 64, v2
  s_branch L_e0
L_x6:
  v_mfma_f32_16x16x32_bf16 v[8:11], v[192:195], v[64:67], 0
  v_mfma_f32_16x16x32_bf16 v[8:11], v[196:199], v[68:71], v[8:11]
  v_mfma_f32_16x16x32_bf16 v[8:11], v[200:203], v[72:75], v[8:11]
  v_mfma_f32_16x16x32_bf16 v[8:11], v[204:207], v[76:79], v[8:11]
  v_mfma_f32_16x16x32_bf16 v[12:15], v[208:211], v[64:67], 0
  v_mfma_f32_16x16x32_bf16 v[12:15], v[212:215], v[68:71], v[12:15]
  v_mfma_f32_16x16x32_bf16 v[12:15], v[216:219], v[72:75], v[12:15]
  v_mfma_f32_16x16x32_bf16 v[12:15], v[220:223], v[76:79], v[12:15]
  s_nop 3
  v_mov_b32_dpp v16, v8 quad_perm:[0,0,2,2] row_mask:0xf bank_mask:0xf
  v_mov_b32_dpp v17, v10 quad_perm:[0,0,2,2] row_mask:0xf bank_mask:0xf
  s_nop 0
  v_add_f32_dpp v16, v9, v16 quad_perm:[1,1,3,3] row_mask:0xf bank_mask:0xf
  v_add_f32_dpp v17, v11, v17 quad_perm:[1,1,3,3] row_mask:0xf bank_mask:0xf
  v_cvt_pk_bf16_f32 v20, v16, v17
  v_max3_f32 v58, v16, v17, v58
  v_mov_b32_dpp v18, v12 quad_perm:[0,0,2,2] row_mask:0xf bank_mask:0xf
  v_mov_b32_dpp v19, v14 quad_perm:[0,0,2,2] row_mask:0xf bank_mask:0xf
  s_nop 0
  v_add_f32_dpp v18, v13, v18 quad_perm:[1,1,3,3] row_mask:0xf bank_mask:0xf
  v_add_f32_dpp v19, v15, v19 quad_perm:[1,1,3,3] row_mask:0xf bank_mask:0xf
  v_cvt_pk_bf16_f32 v21, v18, v19
  v_max3_f32 v58, v18, v19, v58
  ds_write_b64 v2, v[20:21]
  v_add_u32 v2, 64, v2
  s_branch L_e0
L_x7:
  v_mfma_f32_16x16x32_bf16 v[8:11], v[224:227], v[64:67], 0
  v_mfma_f32_16x16x32_bf16 v[8:11], v[228:231], v[68:71], v[8:11]
  v_mfma_f32_16x16x32_bf16 v[8:11], v[232:235], v[72:75], v[8:11]
  v_mfma_f32_16x16x32_bf16 v[8:11], v[236:239], v[76:79], v[8:11]
  v_mfma_f32_16x16x32_bf16 v[12:15], v[240:243], v[64:67], 0
  v_mfma_f32_16x16x32_bf16 v[12:15], v[244:247], v[68:71], v[12:15]
  v_mfma_f32_16x16x32_bf16 v[12:15], v[248:251], v[72:75], v[12:15]
  v_mfma_f32_16x16x32_bf16 v[12:15], v[252:255], v[76:79], v[12:15]
  s_nop 3
  v_mov_b32_dpp v16, v8 quad_perm:[0,0,2,2] row_mask:0xf bank_mask:0xf
  v_mov_b32_dpp v17, v10 quad_perm:[0,0,2,2] row_mask:0xf bank_mask:0xf
  s_nop 0
  v_add_f32_dpp v16, v9, v16 quad_perm:[1,1,3,3] row_mask:0xf bank_mask:0xf
  v_add_f32_dpp v17, v11, v17 quad_perm:[1,1,3,3] row_mask:0xf bank_mask:0xf
  v_cvt_pk_bf16_f32 v20, v16, v17
  v_max3_f32 v58, v16, v17, v58
  v_mov_b32_dpp v18, v12 quad_perm:[0,0,2,2] row_mask:0xf bank_mask:0xf
  v_mov_b32_dpp v19, v14 quad_perm:[0,0,2,2] row_mask:0xf bank_mask:0xf
  s_nop 0
  v_add_f32_dpp v18, v13, v18 quad_perm:[1,1,3,3] row_mask:0xf bank_mask:0xf
  v_add_f32_dpp v19, v15, v19 quad_perm:[1,1,3,3] row_mask:0xf bank_mask:0xf
  v_cvt_pk_bf16_f32 v21, v18, v19
  v_max3_f32 v58, v18, v19, v58
  ds_write_b64 v2, v[20:21]
  v_add_u32 v2, 64, v2
  s_branch L_xr
L_xs:
  s_waitcnt lgkmcnt(0)
  v_mfma_f32_16x16x32_bf16 v[8:11], a[96:99], v[64:67], 0
  v_mfma_f32_16x16x32_bf16 v[8:11], a[100:103], v[68:71], v[8:11]
  v_mfma_f32_16x16x32_bf16 v[8:11], a[104:107], v[72:75], v[8:11]
  v_mfma_f32_16x16x32_bf16 v[8:11], a[108:111], v[76:79], v[8:11]
  v_mfma_f32_16x16x32_bf16 v[12:15], a[112:115], v[64:67], 0
  v_mfma_f32_16x16x32_bf16 v[12:15], a[116:119], v[68:71], v[12:15]
  v_mfma_f32_16x16x32_bf16 v[12:15], a[120:123], v[72:75], v[12:15]
  v_mfma_f32_16x16x32_bf16 v[12:15], a[124:127], v[76:79], v[12:15]
  s_nop 3
  v_mov_b32_dpp v16, v8 quad_perm:[0,0,2,2] row_mask:0xf bank_mask:0xf
  v_mov_b32_dpp v17, v10 quad_perm:[0,0,2,2] row_mask:0xf bank_mask:0xf
  s_nop 0
  v_add_f32_dpp v16, v9, v16 quad_perm:[1,1,3,3] row_mask:0xf bank_mask:0xf
  v_add_f32_dpp v17, v11, v17 quad_perm:[1,1,3,3] row_mask:0xf bank_mask:0xf
  v_cvt_pk_bf16_f32 v20, v16, v17
  v_max3_f32 v58, v16, v17, v58
  v_mov_b32_dpp v18, v12 quad_perm:[0,0,2,2] row_mask:0xf bank_mask:0xf
  v_mov_b32_dpp v19, v14 quad_perm:[0,0,2,2] row_mask:0xf bank_mask:0xf
  s_nop 0
  v_add_f32_dpp v18, v13, v18 quad_perm:[1,1,3,3] row_mask:0xf bank_mask:0xf
  v_add_f32_dpp v19, v15, v19 quad_perm:[1,1,3,3] row_mask:0xf bank_mask:0xf
  v_cvt_pk_bf16_f32 v21, v18, v19
  v_max3_f32 v58, v18, v19, v58
  ds_write_b64 v2, v[20:21]
  v_add_u32 v2, 64, v2
  s_cmp_eq_u32 s58, s70
  s_cbranch_scc1 L_k0
L_xr:
  ds_read_b128 a[96:99], v125 offset:0
  ds_read_b128 a[100:103], v125 offset:1024
  ds_read_b128 a[104:107], v125 offset:2048
  ds_read_b128 a[108:111], v125 offset:3072
  ds_read_b128 a[112:115], v125 offset:4096
  ds_read_b128 a[116:119], v125 offset:5120
  ds_read_b128 a[120:123], v125 offset:6144
  ds_read_b128 a[124:127], v125 offset:7168
  v_add_u32 v125, 0x2000, v125
  s_branch L_e0
L_cx_end:
.p2alignl 12, 0xbf810000
L_cv0:
  s_cbranch_execz L_cv_ret
L_v0:
  s_sub_u32 s73, s73, 1
  s_cbranch_scc1 L_ls_v0
L_lb_v0:
  s_waitcnt lgkmcnt(1)
  v_lshlrev_b32 v16, 16, v22
  v_and_b32 v17, 0xffff0000, v22
  v_lshlrev_b32 v18, 16, v23
  v_and_b32 v19, 0xffff0000, v23
  v_add_u32 v3, 64, v3
  v_sub_f32 v16, v16, v56
  v_sub_f32 v17, v17, v56
  v_sub_f32 v18, v18, v56
  v_sub_f32 v19, v19, v56
  ds_read_b64 v[22:23], v3
  ds_read_b32 v62, v3
  v_mul_f32 v16, s57, v16
  v_mul_f32 v17, s57, v17
  v_mul_f32 v18, s57, v18
  v_mul_f32 v19, s57, v19
  v_exp_f32 v16, v16
  v_exp_f32 v17, v17
  v_exp_f32 v18, v18
  v_exp_f32 v19, v19
  v_cvt_pk_bf16_f32 v40, v16, v16
  v_and_b32 v24, v40, v4
  v_and_b32 v25, v40, v5
  v_and_b32 v26, v40, v6
  v_and_b32 v27, v40, v7
  v_cvt_pk_bf16_f32 v41, v17, v17
  s_waitcnt vmcnt(19)
  v_mfma_f32_16x16x32_bf16 v[32:35], v[24:27], a[0:3], v[32:35]
  buffer_load_dwordx4 a[0:3], v44, s[36:39], s54 offen offset:0 nt
  v_and_b32 v28, v41, v4
  v_and_b32 v29, v41, v5
  v_and_b32 v30, v41, v6
  v_and_b32 v31, v41, v7
  s_waitcnt vmcnt(20)
  v_mfma_f32_16x16x32_bf16 v[36:39], v[24:27], a[4:7], v[36:39]
  buffer_load_dwordx4 a[4:7], v44, s[36:39], s54 offen offset:256 nt
  v_cvt_pk_bf16_f32 v42, v18, v18
  v_add_f32 v16, v16, v17
  s_waitcnt vmcnt(19)
  v_mfma_f32_16x16x32_bf16 v[32:35], v[28:31], a[8:11], v[32:35]
  buffer_load_dwordx4 a[8:11], v45, s[36:39], s54 offen offset:0 nt
  v_and_b32 v24, v42, v4
  v_and_b32 v25, v42, v5
  v_and_b32 v26, v42, v6
  v_and_b32 v27, v42, v7
  s_waitcnt vmcnt(20)
  v_mfma_f32_16x16x32_bf16 v[36:39], v[28:31], a[12:15], v[36:39]
  buffer_load_dwordx4 a[12:15], v45, s[36:39], s54 offen offset:256 nt
  v_cvt_pk_bf16_f32 v43, v19, v19
  v_add_f32 v18, v18, v19
  s_waitcnt vmcnt(19)
  v_mfma_f32_16x16x32_bf16 v[32:35], v[24:27], a[16:19], v[32:35]
  buffer_load_dwordx4 a[16:19], v46, s[36:39], s54 offen offset:0 nt
  v_and_b32 v28, v43, v4
  v_and_b32 v29, v43, v5
  v_and_b32 v30, v43, v6
  v_and_b32 v31, v43, v7
  s_waitcnt vmcnt(20)
  v_mfma_f32_16x16x32_bf16 v[36:39], v[24:27], a[20:23], v[36:39]
  buffer_load_dwordx4 a[20:23], v46, s[36:39], s54 offen offset:256 nt
  v_add_f32 v16, v16, v18
  v_add_f32 v57, v57, v16
  s_waitcnt vmcnt(19)
  v_mfma_f32_16x16x32_bf16 v[32:35], v[28:31], a[24:27], v[32:35]
  buffer_load_dwordx4 a[24:27], v47, s[36:39], s54 offen offset:0 nt
  s_waitcnt vmcnt(20)
  v_mfma_f32_16x16x32_bf16 v[36:39], v[28:31], a[28:31], v[36:39]
  buffer_load_dwordx4 a[28:31], v47, s[36:39], s54 offen offset:256 nt
  s_sub_u32 s72, s72, 1
  s_cmp_eq_u32 s72, 0
  s_cbranch_scc1 L_nxt1
  s_add_u32 s89, s89, 1
  v_readlane_b32 s54, v124, s89
  s_bitcmp1_b32 s89, 6
  s_cselect_b32 s60, s53, s52
  s_add_u32 s54, s54, s60
L_v1:
  s_sub_u32 s73, s73, 1
  s_cbranch_scc1 L_ls_v1
L_lb_v1:
  s_waitcnt lgkmcnt(1)
  v_lshlrev_b32 v16, 16, v22
  v_and_b32 v17, 0xffff0000, v22
  v_lshlrev_b32 v18, 16, v23
  v_and_b32 v19, 0xffff0000, v23
  v_add_u32 v3, 64, v3
  v_sub_f32 v16, v16, v56
  v_sub_f32 v17, v17, v56
  v_sub_f32 v18, v18, v56
  v_sub_f32 v19, v19, v56
  ds_read_b64 v[22:23], v3
  ds_read_b32 v62, v3
  v_mul_f32 v16, s57, v16
  v_mul_f32 v17, s57, v17
  v_mul_f32 v18, s57, v18
  v_mul_f32 v19, s57, v19
  v_exp_f32 v16, v16
  v_exp_f32 v17, v17
  v_exp_f32 v18, v18
  v_exp_f32 v19, v19
  v_cvt_pk_bf16_f32 v40, v16, v16
  v_and_b32 v24, v40, v4
  v_and_b32 v25, v40, v5
  v_and_b32 v26, v40, v6
  v_and_b32 v27, v40, v7
  v_cvt_pk_bf16_f32 v41, v17, v17
  s_waitcnt vmcnt(19)
  v_mfma_f32_16x16x32_bf16 v[32:35], v[24:27], a[32:35], v[32:35]
  buffer_load_dwordx4 a[32:35], v44, s[36:39], s54 offen offset:0 nt
  v_and_b32 v28, v41, v4
  v_and_b32 v29, v41, v5
  v_and_b32 v30, v41, v6
  v_and_b32 v31, v41, v7
  s_waitcnt vmcnt(20)
  v_mfma_f32_16x16x32_bf16 v[36:39], v[24:27], a[36:39], v[36:39]
  buffer_load_dwordx4 a[36:39], v44, s[36:39], s54 offen offset:256 nt
  v_cvt_pk_bf16_f32 v42, v18, v18
  v_add_f32 v16, v16, v17
  s_waitcnt vmcnt(19)
  v_mfma_f32_16x16x32_bf16 v[32:35], v[28:31], a[40:43], v[32:35]
  buffer_load_dwordx4 a[40:43], v45, s[36:39], s54 offen offset:0 nt
  v_and_b32 v24, v42, v4
  v_and_b32 v25, v42, v5
  v_and_b32 v26, v42, v6
  v_and_b32 v27, v42, v7
  s_waitcnt vmcnt(20)
  v_mfma_f32_16x16x32_bf16 v[36:39], v[28:31], a[44:47], v[36:39]
  buffer_load_dwordx4 a[44:47], v45, s[36:39], s54 offen offset:256 nt
  v_cvt_pk_bf16_f32 v43, v19, v19
  v_add_f32 v18, v18, v19
  s_waitcnt vmcnt(19)
  v_mfma_f32_16x16x32_bf16 v[32:35], v[24:27], a[48:51], v[32:35]
  buffer_load_dwordx4 a[48:51], v46, s[36:39], s54 offen offset:0 nt
  v_and_b32 v28, v43, v4
  v_and_b32 v29, v43, v5
  v_and_b32 v30, v43, v6
  v_and_b32 v31, v43, v7
  s_waitcnt vmcnt(20)
  v_mfma_f32_16x16x32_bf16 v[36:39], v[24:27], a[52:55], v[36:39]
  buffer_load_dwordx4 a[52:55], v46, s[36:39], s54 offen offset:256 nt
  v_add_f32 v16, v16, v18
  v_add_f32 v57, v57, v16
  s_waitcnt vmcnt(19)
  v_mfma_f32_16x16x32_bf16 v[32:35], v[28:31], a[56:59], v[32:35]
  buffer_load_dwordx4 a[56:59], v47, s[36:39], s54 offen offset:0 nt
  s_waitcnt vmcnt(20)
  v_mfma_f32_16x16x32_bf16 v[36:39], v[28:31], a[60:63], v[36:39]
  buffer_load_dwordx4 a[60:63], v47, s[36:39], s54 offen offset:256 nt
  s_sub_u32 s72, s72, 1
  s_cmp_eq_u32 s72, 0
  s_cbranch_scc1 L_nxt2
  s_add_u32 s89, s89, 1
  v_readlane_b32 s54, v124, s89
  s_bitcmp1_b32 s89, 6
  s_cselect_b32 s60, s53, s52
  s_add_u32 s54, s54, s60
L_cv1:
  s_cbranch_execz L_cv0
L_v2:
  s_sub_u32 s73, s73, 1
  s_cbranch_scc1 L_ls_v2
L_lb_v2:
  s_waitcnt lgkmcnt(1)
  v_lshlrev_b32 v16, 16, v22
  v_and_b32 v17, 0xffff0000, v22
  v_lshlrev_b32 v18, 16, v23
  v_and_b32 v19, 0xffff0000, v23
  v_add_u32 v3, 64, v3
  v_sub_f32 v16, v16, v56
  v_sub_f32 v17, v17, v56
  v_sub_f32 v18, v18, v56
  v_sub_f32 v19, v19, v56
  ds_read_b64 v[22:23], v3
  ds_read_b32 v62, v3
  v_mul_f32 v16, s57, v16
  v_mul_f32 v17, s57, v17
  v_mul_f32 v18, s57, v18
  v_mul_f32 v19, s57, v19
  v_exp_f32 v16, v16
  v_exp_f32 v17, v17
  v_exp_f32 v18, v18
  v_exp_f32 v19, v19
  v_cvt_pk_bf16_f32 v40, v16, v16
  v_and_b32 v24, v40, v4
  v_and_b32 v25, v40, v5
  v_and_b32 v26, v40, v6
  v_and_b32 v27, v40, v7
  v_cvt_pk_bf16_f32 v41, v17, v17
  s_waitcnt vmcnt(19)
  v_mfma_f32_16x16x32_bf16 v[32:35], v[24:27], a[64:67], v[32:35]
  buffer_load_dwordx4 a[64:67], v44, s[36:39], s54 offen offset:0 nt
  v_and_b32 v28, v41, v4
  v_and_b32 v29, v41, v5
  v_and_b32 v30, v41, v6
  v_and_b32 v31, v41, v7
  s_waitcnt vmcnt(20)
  v_mfma_f32_16x16x32_bf16 v[36:39], v[24:27], a[68:71], v[36:39]
  buffer_load_dwordx4 a[68:71], v44, s[36:39], s54 offen offset:256 nt
  v_cvt_pk_bf16_f32 v42, v18, v18
  v_add_f32 v16, v16, v17
  s_waitcnt vmcnt(19)
  v_mfma_f32_16x16x32_bf16 v[32:35], v[28:31], a[72:75], v[32:35]
  buffer_load_dwordx4 a[72:75], v45, s[36:39], s54 offen offset:0 nt
  v_and_b32 v24, v42, v4
  v_and_b32 v25, v42, v5
  v_and_b32 v26, v42, v6
  v_and_b32 v27, v42, v7
  s_waitcnt vmcnt(20)
  v_mfma_f32_16x16x32_bf16 v[36:39], v[28:31], a[76:79], v[36:39]
  buffer_load_dwordx4 a[76:79], v45, s[36:39], s54 offen offset:256 nt
  v_cvt_pk_bf16_f32 v43, v19, v19
  v_add_f32 v18, v18, v19
  s_waitcnt vmcnt(19)
  v_mfma_f32_16x16x32_bf16 v[32:35], v[24:27], a[80:83], v[32:35]
  buffer_load_dwordx4 a[80:83], v46, s[36:39], s54 offen offset:0 nt
  v_and_b32 v28, v43, v4
  v_and_b32 v29, v43, v5
  v_and_b32 v30, v43, v6
  v_and_b32 v31, v43, v7
  s_waitcnt vmcnt(20)
  v_mfma_f32_16x16x32_bf16 v[36:39], v[24:27], a[84:87], v[36:39]
  buffer_load_dwordx4 a[84:87], v46, s[36:39], s54 offen offset:256 nt
  v_add_f32 v16, v16, v18
  v_add_f32 v57, v57, v16
  s_waitcnt vmcnt(19)
  v_mfma_f32_16x16x32_bf16 v[32:35], v[28:31], a[88:91], v[32:35]
  buffer_load_dwordx4 a[88:91], v47, s[36:39], s54 offen offset:0 nt
  s_waitcnt vmcnt(20)
  v_mfma_f32_16x16x32_bf16 v[36:39], v[28:31], a[92:95], v[36:39]
  buffer_load_dwordx4 a[92:95], v47, s[36:39], s54 offen offset:256 nt
  s_sub_u32 s72, s72, 1
  s_cmp_eq_u32 s72, 0
  s_cbranch_scc1 L_nxt0
  s_add_u32 s89, s89, 1
  v_readlane_b32 s54, v124, s89
  s_bitcmp1_b32 s89, 6
  s_cselect_b32 s60, s53, s52
  s_add_u32 s54, s54, s60
  s_branch L_v0
L_nxt0:
  s_sub_u32 s75, s75, 1
  s_cbranch_scc1 L_sdone
  s_mov_b32 s72, 1
  s_branch L_k0
L_nxt1:
  s_sub_u32 s75, s75, 1
  s_cbranch_scc1 L_sdone
  s_mov_b32 s72, 1
  s_branch L_k1
L_nxt2:
  s_sub_u32 s75, s75, 1
  s_cbranch_scc1 L_sdone
  s_mov_b32 s72, 1
  s_branch L_k2
L_mid0:
  s_call_b64 s[62:63], L_mid
  s_branch L_v0
L_mid1:
  s_call_b64 s[62:63], L_mid
  s_branch L_v1
L_mid2:
  s_call_b64 s[62:63], L_mid
  s_branch L_v2
L_ls_k0:
  s_call_b64 s[62:63], L_ls
  s_branch L_lb_k0
L_ls_k1:
  s_call_b64 s[62:63], L_ls
  s_branch L_lb_k1
L_ls_k2:
  s_call_b64 s[62:63], L_ls
  s_branch L_lb_k2
L_ls_v0:
  s_call_b64 s[62:63], L_ls
  s_cmp_eq_u32 s79, 5
  s_cbranch_scc1 L_dr0
  s_branch L_lb_v0
L_ls_v1:
  s_call_b64 s[62:63], L_ls
  s_cmp_eq_u32 s79, 5
  s_cbranch_scc1 L_dr1
  s_branch L_lb_v1
L_ls_v2:
  s_call_b64 s[62:63], L_ls
  s_cmp_eq_u32 s79, 5
  s_cbranch_scc1 L_dr2
  s_branch L_lb_v2
L_cv2:
  s_cbranch_execz L_cv1
L_mid:
  s_cmp_ge_u32 s79, 2
  s_cbranch_scc1 L_midp
  ds_read_b64 v[22:23], v3
  ds_read_b32 v62, v3
  v_mov_b32 v59, v58
  s_mov_b32 s72, s55
  s_nop 0
  v_permlane32_swap_b32 v59, v58
  v_max_f32 v58, v58, v59
  v_mov_b32 v59, v58
  s_nop 1
  v_permlane16_swap_b32 v59, v58
  v_max_f32 v58, v58, v59
  v_cvt_pk_bf16_f32 v56, v58, v58
  v_lshlrev_b32 v56, 16, v56
L_mid_ret:
  s_setpc_b64 s[62:63]
L_midp:
  s_waitcnt lgkmcnt(1)
  v_mov_b32 v22, v20
  v_mov_b32 v23, v21
  v_subrev_u32 v1, 64, v1
  v_subrev_u32 v3, 64, v3
  v_cvt_pk_bf16_f32 v18, v58, v58
  v_lshlrev_b32 v18, 16, v18
  s_mov_b32 s72, 1
  v_cmp_gt_f32 vcc, v18, v56
  s_cbranch_vccz L_mid_ret
L_resc:
  v_mov_b32 v59, v18
  s_nop 1
  v_permlane32_swap_b32 v59, v18
  v_max_f32 v18, v18, v59
  v_mov_b32 v59, v18
  s_nop 1
  v_permlane16_swap_b32 v59, v18
  v_max3_f32 v18, v18, v59, v56
  v_sub_f32 v59, v56, v18
  v_mul_f32 v59, s57, v59
  v_exp_f32 v59, v59
  v_mov_b32 v56, v18
  v_mul_f32 v57, v57, v59
  v_readlane_b32 s60, v59, 0
  v_readlane_b32 s61, v59, 8
  s_nop 0
  v_mov_b32 v59, s60
  s_mov_b32 exec_lo, 0
  v_mov_b32 v59, s61
  s_mov_b64 exec, -1
  v_mul_f32 v32, v32, v59
  v_mul_f32 v33, v33, v59
  v_mul_f32 v34, v34, v59
  v_mul_f32 v35, v35, v59
  v_mul_f32 v36, v36, v59
  v_mul_f32 v37, v37, v59
  v_mul_f32 v38, v38, v59
  v_mul_f32 v39, v39, v59
L_mid_ret2:
  s_setpc_b64 s[62:63]
L_ls:
  s_cmp_eq_u32 s79, 2
  s_cbranch_scc1 L_ls2
  s_cmp_eq_u32 s79, 1
  s_cbranch_scc1 L_ls1
  s_mov_b64 s[36:37], s[40:41]
  v_mov_b32 v44, v52
  v_mov_b32 v45, v53
  v_mov_b32 v46, v54
  v_mov_b32 v47, v55
  s_mov_b32 s54, s74
  s_mov_b32 s89, 0
  s_sub_u32 s60, s55, 3
  s_cmp_eq_u32 s79, 0
  s_cselect_b32 s73, s60, 0
  s_cselect_b32 s79, 1, 2
  s_setpc_b64 s[62:63]
L_ls1:
  s_mov_b32 s73, 1
  s_mov_b32 s79, 2
  s_branch L_claim
L_ls2:
  s_waitcnt lgkmcnt(0)
  s_cmp_ge_u32 s78, 96
  s_cbranch_scc1 L_ls_end
  s_lshr_b32 s60, s78, 1
  v_readlane_b32 s54, v126, s60
  s_lshl_b32 s60, s78, 4
  s_lshr_b32 s54, s54, s60
  s_and_b32 s54, s54, 0xffff
  s_lshl_b32 s54, s54, 9
  s_mov_b32 s74, s54
  s_mov_b64 s[36:37], s[42:43]
  v_mov_b32 v44, v48
  v_mov_b32 v45, v49
  v_mov_b32 v46, v50
  v_mov_b32 v47, v51
  s_add_u32 s75, s75, 1
  s_mov_b32 s73, 0
  s_mov_b32 s79, 3
L_claim:
  s_mov_b32 s78, 1
  s_atomic_add s78, s[28:29], s77 glc
L_ls_ret:
  s_setpc_b64 s[62:63]
L_ls_end:
  s_mov_b32 s38, 0
  s_movk_i32 s73, 0x7fff
  s_add_u32 s79, s75, 4
  s_sub_u32 s60, s34, 1
  s_cmp_lt_u32 s60, 2
  s_cbranch_scc0 L_ls_ret
  s_barrier
  s_setpc_b64 s[62:63]
L_sdone:
  v_mov_b32 v21, v57
  v_mov_b32 v24, v56
  v_mov_b32 v26, s49
  v_permlane32_swap_b32 v21, v57
  s_movk_i32 s61, 0xff
  v_add_f32 v57, v57, v21
  v_mov_b32 v21, v57
  v_bfi_b32 v32, s61, v26, v32
  global_store_dwordx4 v80, v[32:35], s[28:29] sc1
  v_permlane16_swap_b32 v21, v57
  v_bfi_b32 v36, s61, v26, v36
  global_store_dwordx4 v82, v[36:39], s[28:29] sc1
  v_add_f32 v25, v57, v21
  s_mov_b64 exec, 0x101
  global_store_dwordx4 v81, v[24:27], s[28:29] sc1
  s_mov_b64 exec, -1
  s_sub_u32 s60, s34, 1
  s_cmp_lt_u32 s60, 2
  s_cbranch_scc1 L_tail
  s_endpgm
L_cv_end:
.p2alignl 12, 0xbf810000
L_cd0:
  s_cbranch_execz L_cd_ret
L_dr0:
  s_waitcnt lgkmcnt(1)
  v_lshlrev_b32 v16, 16, v22
  v_and_b32 v17, 0xffff0000, v22
  v_lshlrev_b32 v18, 16, v23
  v_and_b32 v19, 0xffff0000, v23
  v_sub_f32 v16, v16, v56
  v_sub_f32 v17, v17, v56
  v_sub_f32 v18, v18, v56
  v_sub_f32 v19, v19, v56
  v_mul_f32 v16, s57, v16
  v_mul_f32 v17, s57, v17
  v_mul_f32 v18, s57, v18
  v_mul_f32 v19, s57, v19
  v_exp_f32 v16, v16
  v_exp_f32 v17, v17
  v_exp_f32 v18, v18
  v_exp_f32 v19, v19
  v_cvt_pk_bf16_f32 v40, v16, v16
  v_and_b32 v24, v40, v4
  v_and_b32 v25, v40, v5
  v_and_b32 v26, v40, v6
  v_and_b32 v27, v40, v7
  v_cvt_pk_bf16_f32 v41, v17, v17
  s_waitcnt vmcnt(23)
  v_mfma_f32_16x16x32_bf16 v[32:35], v[24:27], a[0:3], v[32:35]
  v_and_b32 v28, v41, v4
  v_and_b32 v29, v41, v5
  v_and_b32 v30, v41, v6
  v_and_b32 v31, v41, v7
  s_waitcnt vmcnt(22)
  v_mfma_f32_16x16x32_bf16 v[36:39], v[24:27], a[4:7], v[36:39]
  v_cvt_pk_bf16_f32 v42, v18, v18
  v_add_f32 v16, v16, v17
  s_waitcnt vmcnt(21)
  v_mfma_f32_16x16x32_bf16 v[32:35], v[28:31], a[8:11], v[32:35]
  v_and_b32 v24, v42, v4
  v_and_b32 v25, v42, v5
  v_and_b32 v26, v42, v6
  v_and_b32 v27, v42, v7
  s_waitcnt vmcnt(20)
  v_mfma_f32_16x16x32_bf16 v[36:39], v[28:31], a[12:15], v[36:39]
  v_cvt_pk_bf16_f32 v43, v19, v19
  v_add_f32 v18, v18, v19
  s_waitcnt vmcnt(19)
  v_mfma_f32_16x16x32_bf16 v[32:35], v[24:27], a[16:19], v[32:35]
  v_and_b32 v28, v43, v4
  v_and_b32 v29, v43, v5
  v_and_b32 v30, v43, v6
  v_and_b32 v31, v43, v7
  s_waitcnt vmcnt(18)
  v_mfma_f32_16x16x32_bf16 v[36:39], v[24:27], a[20:23], v[36:39]
  v_add_f32 v16, v16, v18
  v_add_f32 v57, v57, v16
  s_waitcnt vmcnt(17)
  v_mfma_f32_16x16x32_bf16 v[32:35], v[28:31], a[24:27], v[32:35]
  s_waitcnt vmcnt(16)
  v_mfma_f32_16x16x32_bf16 v[36:39], v[28:31], a[28:31], v[36:39]
  s_waitcnt vmcnt(15)
  v_mfma_f32_16x16x32_bf16 v[8:11], a[32:35], v[64:67], 0
  s_waitcnt vmcnt(14)
  v_mfma_f32_16x16x32_bf16 v[8:11], a[36:39], v[68:71], v[8:11]
  s_waitcnt vmcnt(13)
  v_mfma_f32_16x16x32_bf16 v[8:11], a[40:43], v[72:75], v[8:11]
  s_waitcnt vmcnt(12)
  v_mfma_f32_16x16x32_bf16 v[8:11], a[44:47], v[76:79], v[8:11]
  s_waitcnt vmcnt(11)
  v_mfma_f32_16x16x32_bf16 v[12:15], a[48:51], v[64:67], 0
  s_waitcnt vmcnt(10)
  v_mfma_f32_16x16x32_bf16 v[12:15], a[52:55], v[68:71], v[12:15]
  s_waitcnt vmcnt(9)
  v_mfma_f32_16x16x32_bf16 v[12:15], a[56:59], v[72:75], v[12:15]
  s_waitcnt vmcnt(8)
  v_mfma_f32_16x16x32_bf16 v[12:15], a[60:63], v[76:79], v[12:15]
  v_mov_b32_dpp v16, v8 quad_perm:[0,0,2,2] row_mask:0xf bank_mask:0xf
  v_mov_b32_dpp v17, v10 quad_perm:[0,0,2,2] row_mask:0xf bank_mask:0xf
  s_nop 0
  v_add_f32_dpp v16, v9, v16 quad_perm:[1,1,3,3] row_mask:0xf bank_mask:0xf
  v_add_f32_dpp v17, v11, v17 quad_perm:[1,1,3,3] row_mask:0xf bank_mask:0xf
  v_cvt_pk_bf16_f32 v20, v16, v17
  v_max3_f32 v58, v16, v17, v58
  s_nop 0
  v_mov_b32_dpp v18, v12 quad_perm:[0,0,2,2] row_mask:0xf bank_mask:0xf
  v_mov_b32_dpp v19, v14 quad_perm:[0,0,2,2] row_mask:0xf bank_mask:0xf
  s_nop 0
  v_add_f32_dpp v18, v13, v18 quad_perm:[1,1,3,3] row_mask:0xf bank_mask:0xf
  v_add_f32_dpp v19, v15, v19 quad_perm:[1,1,3,3] row_mask:0xf bank_mask:0xf
  v_cvt_pk_bf16_f32 v21, v18, v19
  v_max3_f32 v58, v18, v19, v58
  v_cvt_pk_bf16_f32 v18, v58, v58
  v_lshlrev_b32 v18, 16, v18
  v_cmp_gt_f32 vcc, v18, v56
  s_cbranch_vccnz L_drr0
L_drb0:
  v_lshlrev_b32 v16, 16, v20
  v_and_b32 v17, 0xffff0000, v20
  v_lshlrev_b32 v18, 16, v21
  v_and_b32 v19, 0xffff0000, v21
  v_sub_f32 v16, v16, v56
  v_sub_f32 v17, v17, v56
  v_sub_f32 v18, v18, v56
  v_sub_f32 v19, v19, v56
  v_mul_f32 v16, s57, v16
  v_mul_f32 v17, s57, v17
  v_mul_f32 v18, s57, v18
  v_mul_f32 v19, s57, v19
  v_exp_f32 v16, v16
  v_exp_f32 v17, v17
  v_exp_f32 v18, v18
  v_exp_f32 v19, v19
  v_cvt_pk_bf16_f32 v40, v16, v16
  v_and_b32 v24, v40, v4
  v_and_b32 v25, v40, v5
  v_and_b32 v26, v40, v6
  v_and_b32 v27, v40, v7
  v_cvt_pk_bf16_f32 v41, v17, v17
  s_waitcnt vmcnt(7)
  v_mfma_f32_16x16x32_bf16 v[32:35], v[24:27], a[64:67], v[32:35]
  v_and_b32 v28, v41, v4
  v_and_b32 v29, v41, v5
  v_and_b32 v30, v41, v6
  v_and_b32 v31, v41, v7
  s_waitcnt vmcnt(6)
  v_mfma_f32_16x16x32_bf16 v[36:39], v[24:27], a[68:71], v[36:39]
  v_cvt_pk_bf16_f32 v42, v18, v18
  v_add_f32 v16, v16, v17
  s_waitcnt vmcnt(5)
  v_mfma_f32_16x16x32_bf16 v[32:35], v[28:31], a[72:75], v[32:35]
  v_and_b32 v24, v42, v4
  v_and_b32 v25, v42, v5
  v_and_b32 v26, v42, v6
  v_and_b32 v27, v42, v7
  s_waitcnt vmcnt(4)
  v_mfma_f32_16x16x32_bf16 v[36:39], v[28:31], a[76:79], v[36:39]
  v_cvt_pk_bf16_f32 v43, v19, v19
  v_add_f32 v18, v18, v19
  s_waitcnt vmcnt(3)
  v_mfma_f32_16x16x32_bf16 v[32:35], v[24:27], a[80:83], v[32:35]
  v_and_b32 v28, v43, v4
  v_and_b32 v29, v43, v5
  v_and_b32 v30, v43, v6
  v_and_b32 v31, v43, v7
  s_waitcnt vmcnt(2)
  v_mfma_f32_16x16x32_bf16 v[36:39], v[24:27], a[84:87], v[36:39]
  v_add_f32 v16, v16, v18
  v_add_f32 v57, v57, v16
  s_waitcnt vmcnt(1)
  v_mfma_f32_16x16x32_bf16 v[32:35], v[28:31], a[88:91], v[32:35]
  s_waitcnt vmcnt(0)
  v_mfma_f32_16x16x32_bf16 v[36:39], v[28:31], a[92:95], v[36:39]
  s_branch L_sdone
L_drr0:
  s_call_b64 s[62:63], L_resc
  s_branch L_drb0
L_cd1:
  s_cbranch_execz L_cd0
L_dr1:
  s_waitcnt lgkmcnt(1)
  v_lshlrev_b32 v16, 16, v22
  v_and_b32 v17, 0xffff0000, v22
  v_lshlrev_b32 v18, 16, v23
  v_and_b32 v19, 0xffff0000, v23
  v_sub_f32 v16, v16, v56
  v_sub_f32 v17, v17, v56
  v_sub_f32 v18, v18, v56
  v_sub_f32 v19, v19, v56
  v_mul_f32 v16, s57, v16
  v_mul_f32 v17, s57, v17
  v_mul_f32 v18, s57, v18
  v_mul_f32 v19, s57, v19
  v_exp_f32 v16, v16
  v_exp_f32 v17, v17
  v_exp_f32 v18, v18
  v_exp_f32 v19, v19
  v_cvt_pk_bf16_f32 v40, v16, v16
  v_and_b32 v24, v40, v4
  v_and_b32 v25, v40, v5
  v_and_b32 v26, v40, v6
  v_and_b32 v27, v40, v7
  v_cvt_pk_bf16_f32 v41, v17, v17
  s_waitcnt vmcnt(23)
  v_mfma_f32_16x16x32_bf16 v[32:35], v[24:27], a[32:35], v[32:35]
  v_and_b32 v28, v41, v4
  v_and_b32 v29, v41, v5
  v_and_b32 v30, v41, v6
  v_and_b32 v31, v41, v7
  s_waitcnt vmcnt(22)
  v_mfma_f32_16x16x32_bf16 v[36:39], v[24:27], a[36:39], v[36:39]
  v_cvt_pk_bf16_f32 v42, v18, v18
  v_add_f32 v16, v16, v17
  s_waitcnt vmcnt(21)
  v_mfma_f32_16x16x32_bf16 v[32:35], v[28:31], a[40:43], v[32:35]
  v_and_b32 v24, v42, v4
  v_and_b32 v25, v42, v5
  v_and_b32 v26, v42, v6
  v_and_b32 v27, v42, v7
  s_waitcnt vmcnt(20)
  v_mfma_f32_16x16x32_bf16 v[36:39], v[28:31], a[44:47], v[36:39]
  v_cvt_pk_bf16_f32 v43, v19, v19
  v_add_f32 v18, v18, v19
  s_waitcnt vmcnt(19)
  v_mfma_f32_16x16x32_bf16 v[32:35], v[24:27], a[48:51], v[32:35]
  v_and_b32 v28, v43, v4
  v_and_b32 v29, v43, v5
  v_and_b32 v30, v43, v6
  v_and_b32 v31, v43, v7
  s_waitcnt vmcnt(18)
  v_mfma_f32_16x16x32_bf16 v[36:39], v[24:27], a[52:55], v[36:39]
  v_add_f32 v16, v16, v18
  v_add_f32 v57, v57, v16
  s_waitcnt vmcnt(17)
  v_mfma_f32_16x16x32_bf16 v[32:35], v[28:31], a[56:59], v[32:35]
  s_waitcnt vmcnt(16)
  v_mfma_f32_16x16x32_bf16 v[36:39], v[28:31], a[60:63], v[36:39]
  s_waitcnt vmcnt(15)
  v_mfma_f32_16x16x32_bf16 v[8:11], a[64:67], v[64:67], 0
  s_waitcnt vmcnt(14)
  v_mfma_f32_16x16x32_bf16 v[8:11], a[68:71], v[68:71], v[8:11]
  s_waitcnt vmcnt(13)
  v_mfma_f32_16x16x32_bf16 v[8:11], a[72:75], v[72:75], v[8:11]
  s_waitcnt vmcnt(12)
  v_mfma_f32_16x16x32_bf16 v[8:11], a[76:79], v[76:79], v[8:11]
  s_waitcnt vmcnt(11)
  v_mfma_f32_16x16x32_bf16 v[12:15], a[80:83], v[64:67], 0
  s_waitcnt vmcnt(10)
  v_mfma_f32_16x16x32_bf16 v[12:15], a[84:87], v[68:71], v[12:15]
  s_waitcnt vmcnt(9)
  v_mfma_f32_16x16x32_bf16 v[12:15], a[88:91], v[72:75], v[12:15]
  s_waitcnt vmcnt(8)
  v_mfma_f32_16x16x32_bf16 v[12:15], a[92:95], v[76:79], v[12:15]
  v_mov_b32_dpp v16, v8 quad_perm:[0,0,2,2] row_mask:0xf bank_mask:0xf
  v_mov_b32_dpp v17, v10 quad_perm:[0,0,2,2] row_mask:0xf bank_mask:0xf
  s_nop 0
  v_add_f32_dpp v16, v9, v16 quad_perm:[1,1,3,3] row_mask:0xf bank_mask:0xf
  v_add_f32_dpp v17, v11, v17 quad_perm:[1,1,3,3] row_mask:0xf bank_mask:0xf
  v_cvt_pk_bf16_f32 v20, v16, v17
  v_max3_f32 v58, v16, v17, v58
  s_nop 0
  v_mov_b32_dpp v18, v12 quad_perm:[0,0,2,2] row_mask:0xf bank_mask:0xf
  v_mov_b32_dpp v19, v14 quad_perm:[0,0,2,2] row_mask:0xf bank_mask:0xf
  s_nop 0
  v_add_f32_dpp v18, v13, v18 quad_perm:[1,1,3,3] row_mask:0xf bank_mask:0xf
  v_add_f32_dpp v19, v15, v19 quad_perm:[1,1,3,3] row_mask:0xf bank_mask:0xf
  v_cvt_pk_bf16_f32 v21, v18, v19
  v_max3_f32 v58, v18, v19, v58
  v_cvt_pk_bf16_f32 v18, v58, v58
  v_lshlrev_b32 v18, 16, v18
  v_cmp_gt_f32 vcc, v18, v56
  s_cbranch_vccnz L_drr1
L_drb1:
  v_lshlrev_b32 v16, 16, v20
  v_and_b32 v17, 0xffff0000, v20
  v_lshlrev_b32 v18, 16, v21
  v_and_b32 v19, 0xffff0000, v21
  v_sub_f32 v16, v16, v56
  v_sub_f32 v17, v17, v56
  v_sub_f32 v18, v18, v56
  v_sub_f32 v19, v19, v56
  v_mul_f32 v16, s57, v16
  v_mul_f32 v17, s57, v17
  v_mul_f32 v18, s57, v18
  v_mul_f32 v19, s57, v19
  v_exp_f32 v16, v16
  v_exp_f32 v17, v17
  v_exp_f32 v18, v18
  v_exp_f32 v19, v19
  v_cvt_pk_bf16_f32 v40, v16, v16
  v_and_b32 v24, v40, v4
  v_and_b32 v25, v40, v5
  v_and_b32 v26, v40, v6
  v_and_b32 v27, v40, v7
  v_cvt_pk_bf16_f32 v41, v17, v17
  s_waitcnt vmcnt(7)
  v_mfma_f32_16x16x32_bf16 v[32:35], v[24:27], a[0:3], v[32:35]
  v_and_b32 v28, v41, v4
  v_and_b32 v29, v41, v5
  v_and_b32 v30, v41, v6
  v_and_b32 v31, v41, v7
  s_waitcnt vmcnt(6)
  v_mfma_f32_16x16x32_bf16 v[36:39], v[24:27], a[4:7], v[36:39]
  v_cvt_pk_bf16_f32 v42, v18, v18
  v_add_f32 v16, v16, v17
  s_waitcnt vmcnt(5)
  v_mfma_f32_16x16x32_bf16 v[32:35], v[28:31], a[8:11], v[32:35]
  v_and_b32 v24, v42, v4
  v_and_b32 v25, v42, v5
  v_and_b32 v26, v42, v6
  v_and_b32 v27, v42, v7
  s_waitcnt vmcnt(4)
  v_mfma_f32_16x16x32_bf16 v[36:39], v[28:31], a[12:15], v[36:39]
  v_cvt_pk_bf16_f32 v43, v19, v19
  v_add_f32 v18, v18, v19
  s_waitcnt vmcnt(3)
  v_mfma_f32_16x16x32_bf16 v[32:35], v[24:27], a[16:19], v[32:35]
  v_and_b32 v28, v43, v4
  v_and_b32 v29, v43, v5
  v_and_b32 v30, v43, v6
  v_and_b32 v31, v43, v7
  s_waitcnt vmcnt(2)
  v_mfma_f32_16x16x32_bf16 v[36:39], v[24:27], a[20:23], v[36:39]
  v_add_f32 v16, v16, v18
  v_add_f32 v57, v57, v16
  s_waitcnt vmcnt(1)
  v_mfma_f32_16x16x32_bf16 v[32:35], v[28:31], a[24:27], v[32:35]
  s_waitcnt vmcnt(0)
  v_mfma_f32_16x16x32_bf16 v[36:39], v[28:31], a[28:31], v[36:39]
  s_branch L_sdone
L_drr1:
  s_call_b64 s[62:63], L_resc
  s_branch L_drb1
L_cd2:
  s_cbranch_execz L_cd1
L_dr2:
  s_waitcnt lgkmcnt(1)
  v_lshlrev_b32 v16, 16, v22
  v_and_b32 v17, 0xffff0000, v22
  v_lshlrev_b32 v18, 16, v23
  v_and_b32 v19, 0xffff0000, v23
  v_sub_f32 v16, v16, v56
  v_sub_f32 v17, v17, v56
  v_sub_f32 v18, v18, v56
  v_sub_f32 v19, v19, v56
  v_mul_f32 v16, s57, v16
  v_mul_f32 v17, s57, v17
  v_mul_f32 v18, s57, v18
  v_mul_f32 v19, s57, v19
  v_exp_f32 v16, v16
  v_exp_f32 v17, v17
  v_exp_f32 v18, v18
  v_exp_f32 v19, v19
  v_cvt_pk_bf16_f32 v40, v16, v16
  v_and_b32 v24, v40, v4
  v_and_b32 v25, v40, v5
  v_and_b32 v26, v40, v6
  v_and_b32 v27, v40, v7
  v_cvt_pk_bf16_f32 v41, v17, v17
  s_waitcnt vmcnt(23)
  v_mfma_f32_16x16x32_bf16 v[32:35], v[24:27], a[64:67], v[32:35]
  v_and_b32 v28, v41, v4
  v_and_b32 v29, v41, v5
  v_and_b32 v30, v41, v6
  v_and_b32 v31, v41, v7
  s_waitcnt vmcnt(22)
  v_mfma_f32_16x16x32_bf16 v[36:39], v[24:27], a[68:71], v[36:39]
  v_cvt_pk_bf16_f32 v42, v18, v18
  v_add_f32 v16, v16, v17
  s_waitcnt vmcnt(21)
  v_mfma_f32_16x16x32_bf16 v[32:35], v[28:31], a[72:75], v[32:35]
  v_and_b32 v24, v42, v4
  v_and_b32 v25, v42, v5
  v_and_b32 v26, v42, v6
  v_and_b32 v27, v42, v7
  s_waitcnt vmcnt(20)
  v_mfma_f32_16x16x32_bf16 v[36:39], v[28:31], a[76:79], v[36:39]
  v_cvt_pk_bf16_f32 v43, v19, v19
  v_add_f32 v18, v18, v19
  s_waitcnt vmcnt(19)
  v_mfma_f32_16x16x32_bf16 v[32:35], v[24:27], a[80:83], v[32:35]
  v_and_b32 v28, v43, v4
  v_and_b32 v29, v43, v5
  v_and_b32 v30, v43, v6
  v_and_b32 v31, v43, v7
  s_waitcnt vmcnt(18)
  v_mfma_f32_16x16x32_bf16 v[36:39], v[24:27], a[84:87], v[36:39]
  v_add_f32 v16, v16, v18
  v_add_f32 v57, v57, v16
  s_waitcnt vmcnt(17)
  v_mfma_f32_16x16x32_bf16 v[32:35], v[28:31], a[88:91], v[32:35]
  s_waitcnt vmcnt(16)
  v_mfma_f32_16x16x32_bf16 v[36:39], v[28:31], a[92:95], v[36:39]
  s_waitcnt vmcnt(15)
  v_mfma_f32_16x16x32_bf16 v[8:11], a[0:3], v[64:67], 0
  s_waitcnt vmcnt(14)
  v_mfma_f32_16x16x32_bf16 v[8:11], a[4:7], v[68:71], v[8:11]
  s_waitcnt vmcnt(13)
  v_mfma_f32_16x16x32_bf16 v[8:11], a[8:11], v[72:75], v[8:11]
  s_waitcnt vmcnt(12)
  v_mfma_f32_16x16x32_bf16 v[8:11], a[12:15], v[76:79], v[8:11]
  s_waitcnt vmcnt(11)
  v_mfma_f32_16x16x32_bf16 v[12:15], a[16:19], v[64:67], 0
  s_waitcnt vmcnt(10)
  v_mfma_f32_16x16x32_bf16 v[12:15], a[20:23], v[68:71], v[12:15]
  s_waitcnt vmcnt(9)
  v_mfma_f32_16x16x32_bf16 v[12:15], a[24:27], v[72:75], v[12:15]
  s_waitcnt vmcnt(8)
  v_mfma_f32_16x16x32_bf16 v[12:15], a[28:31], v[76:79], v[12:15]
  v_mov_b32_dpp v16, v8 quad_perm:[0,0,2,2] row_mask:0xf bank_mask:0xf
  v_mov_b32_dpp v17, v10 quad_perm:[0,0,2,2] row_mask:0xf bank_mask:0xf
  s_nop 0
  v_add_f32_dpp v16, v9, v16 quad_perm:[1,1,3,3] row_mask:0xf bank_mask:0xf
  v_add_f32_dpp v17, v11, v17 quad_perm:[1,1,3,3] row_mask:0xf bank_mask:0xf
  v_cvt_pk_bf16_f32 v20, v16, v17
  v_max3_f32 v58, v16, v17, v58
  s_nop 0
  v_mov_b32_dpp v18, v12 quad_perm:[0,0,2,2] row_mask:0xf bank_mask:0xf
  v_mov_b32_dpp v19, v14 quad_perm:[0,0,2,2] row_mask:0xf bank_mask:0xf
  s_nop 0
  v_add_f32_dpp v18, v13, v18 quad_perm:[1,1,3,3] row_mask:0xf bank_mask:0xf
  v_add_f32_dpp v19, v15, v19 quad_perm:[1,1,3,3] row_mask:0xf bank_mask:0xf
  v_cvt_pk_bf16_f32 v21, v18, v19
  v_max3_f32 v58, v18, v19, v58
  v_cvt_pk_bf16_f32 v18, v58, v58
  v_lshlrev_b32 v18, 16, v18
  v_cmp_gt_f32 vcc, v18, v56
  s_cbranch_vccnz L_drr2
L_drb2:
  v_lshlrev_b32 v16, 16, v20
  v_and_b32 v17, 0xffff0000, v20
  v_lshlrev_b32 v18, 16, v21
  v_and_b32 v19, 0xffff0000, v21
  v_sub_f32 v16, v16, v56
  v_sub_f32 v17, v17, v56
  v_sub_f32 v18, v18, v56
  v_sub_f32 v19, v19, v56
  v_mul_f32 v16, s57, v16
  v_mul_f32 v17, s57, v17
  v_mul_f32 v18, s57, v18
  v_mul_f32 v19, s57, v19
  v_exp_f32 v16, v16
  v_exp_f32 v17, v17
  v_exp_f32 v18, v18
  v_exp_f32 v19, v19
  v_cvt_pk_bf16_f32 v40, v16, v16
  v_and_b32 v24, v40, v4
  v_and_b32 v25, v40, v5
  v_and_b32 v26, v40, v6
  v_and_b32 v27, v40, v7
  v_cvt_pk_bf16_f32 v41, v17, v17
  s_waitcnt vmcnt(7)
  v_mfma_f32_16x16x32_bf16 v[32:35], v[24:27], a[32:35], v[32:35]
  v_and_b32 v28, v41, v4
  v_and_b32 v29, v41, v5
  v_and_b32 v30, v41, v6
  v_and_b32 v31, v41, v7
  s_waitcnt vmcnt(6)
  v_mfma_f32_16x16x32_bf16 v[36:39], v[24:27], a[36:39], v[36:39]
  v_cvt_pk_bf16_f32 v42, v18, v18
  v_add_f32 v16, v16, v17
  s_waitcnt vmcnt(5)
  v_mfma_f32_16x16x32_bf16 v[32:35], v[28:31], a[40:43], v[32:35]
  v_and_b32 v24, v42, v4
  v_and_b32 v25, v42, v5
  v_and_b32 v26, v42, v6
  v_and_b32 v27, v42, v7
  s_waitcnt vmcnt(4)
  v_mfma_f32_16x16x32_bf16 v[36:39], v[28:31], a[44:47], v[36:39]
  v_cvt_pk_bf16_f32 v43, v19, v19
  v_add_f32 v18, v18, v19
  s_waitcnt vmcnt(3)
  v_mfma_f32_16x16x32_bf16 v[32:35], v[24:27], a[48:51], v[32:35]
  v_and_b32 v28, v43, v4
  v_and_b32 v29, v43, v5
  v_and_b32 v30, v43, v6
  v_and_b32 v31, v43, v7
  s_waitcnt vmcnt(2)
  v_mfma_f32_16x16x32_bf16 v[36:39], v[24:27], a[52:55], v[36:39]
  v_add_f32 v16, v16, v18
  v_add_f32 v57, v57, v16
  s_waitcnt vmcnt(1)
  v_mfma_f32_16x16x32_bf16 v[32:35], v[28:31], a[56:59], v[32:35]
  s_waitcnt vmcnt(0)
  v_mfma_f32_16x16x32_bf16 v[36:39], v[28:31], a[60:63], v[36:39]
  s_branch L_sdone
L_drr2:
  s_call_b64 s[62:63], L_resc
  s_branch L_drb2
L_cd_end:
.p2alignl 12, 0xbf810000
L_help:
  s_lshr_b32 s60, s2, 3
  s_bfe_u32 s61, s2, 0x10002
  s_sub_u32 s62, s60, 14
  s_cmp_ge_u32 s60, 14
  s_cselect_b32 s62, s62, s60
  s_cselect_b32 s63, 1, 0
  s_and_b32 s31, s62, 1
  s_lshr_b32 s35, s62, 1
  s_lshl_b32 s64, s61, 1
  s_add_u32 s30, s64, s63
  s_cmp_lt_u32 s60, 28
  s_cselect_b32 s34, 1, 0
  s_bitcmp1_b32 s2, 1
  s_cbranch_scc0 L_r01b
  s_and_b32 s65, s2, 1
  s_add_u32 s64, s64, s65
  s_add_u32 s30, s64, 4
  s_cmp_eq_u32 s63, 0
  s_cbranch_scc1 L_rdb
  s_lshl_b32 s30, s64, 1
  s_bfe_u32 s65, s62, 0x10003
  s_add_u32 s30, s30, s65
  s_and_b32 s35, s62, 7
  s_cmp_lt_u32 s60, 30
  s_cselect_b32 s34, 3, 0
  s_branch L_rdb
L_r01b:
  s_bitcmp1_b32 s2, 0
  s_cbranch_scc1 L_rdb
  s_lshl_b32 s34, s34, 1
  s_mov_b32 s31, s61
  s_mov_b32 s35, s60
L_rdb:
  s_lshl_b32 s33, s31, 3
  s_or_b32 s33, s33, s30
  v_lshrrev_b32 v1, 5, v0
  v_mul_u32_u24 v1, 896, v1
  v_and_b32 v2, 31, v0
  v_lshl_add_u32 v1, v2, 2, v1
  s_waitcnt lgkmcnt(0)
  s_load_dword s50, s[28:29], 0
  s_load_dword s51, s[28:29], 128
  s_cmp_eq_u32 s3, 2
  s_cbranch_scc1 L_w2
  s_cmp_eq_u32 s3, 3
  s_cbranch_scc1 L_w3
  s_cmp_lg_u32 s34, 3
  s_cbranch_scc1 L_w1n
  global_load_dword v8, v1, s[4:5] offset:0
  global_load_dword v9, v1, s[4:5] offset:128
  global_load_dword v10, v1, s[4:5] offset:256
  global_load_dword v11, v1, s[4:5] offset:384
  global_load_dword v12, v1, s[4:5] offset:512
  global_load_dword v13, v1, s[4:5] offset:640
  global_load_dword v14, v1, s[4:5] offset:768
  v_add_u32 v5, 158464, v1
  s_waitcnt vmcnt(0) lgkmcnt(0)
  s_mul_i32 s50, s50, 0x9e3779b1
  s_mul_i32 s51, s51, 0x9e3779b1
  s_add_u32 s50, s50, 0x7f4a7c15
  s_add_u32 s51, s51, 0x7f4a7c15
  s_cmp_eq_u32 s31, 0
  s_cselect_b32 s59, s50, s51
  s_bitcmp0_b32 s2, 3
  s_cselect_b32 s49, s50, s51
  v_lshlrev_b32 v16, 16, v8
  v_and_b32 v17, 0xffff0000, v8
  v_lshlrev_b32 v18, 16, v9
  v_and_b32 v19, 0xffff0000, v9
  v_lshlrev_b32 v20, 16, v10
  v_and_b32 v21, 0xffff0000, v10
  v_lshlrev_b32 v22, 16, v11
  v_and_b32 v23, 0xffff0000, v11
  v_lshlrev_b32 v24, 16, v12
  v_and_b32 v25, 0xffff0000, v12
  v_lshlrev_b32 v26, 16, v13
  v_and_b32 v27, 0xffff0000, v13
  v_lshlrev_b32 v28, 16, v14
  v_and_b32 v29, 0xffff0000, v14
  v_pk_add_f32 v[50:51], v[16:17], v[18:19]
  v_pk_add_f32 v[50:51], v[50:51], v[20:21]
  v_pk_add_f32 v[50:51], v[50:51], v[22:23]
  v_pk_add_f32 v[50:51], v[50:51], v[24:25]
  v_pk_add_f32 v[50:51], v[50:51], v[26:27]
  v_pk_add_f32 v[50:51], v[50:51], v[28:29]
  v_add_f32 v46, v50, v51
  s_nop 1
  v_add_f32_dpp v46, v46, v46 row_ror:8 row_mask:0xf bank_mask:0xf
  s_nop 1
  v_add_f32_dpp v46, v46, v46 row_ror:4 row_mask:0xf bank_mask:0xf
  s_nop 1
  v_add_f32_dpp v46, v46, v46 row_ror:2 row_mask:0xf bank_mask:0xf
  s_nop 1
  v_add_f32_dpp v46, v46, v46 row_ror:1 row_mask:0xf bank_mask:0xf
  v_mov_b32 v47, v46
  s_nop 1
  v_permlane16_swap_b32 v47, v46
  v_add_f32 v46, v46, v47
  v_mul_f32 v46, 0x3b124925, v46
  v_pk_add_f32 v[32:33], v[16:17], v[46:47] op_sel_hi:[1,0] neg_lo:[0,1] neg_hi:[0,1]
  v_pk_add_f32 v[34:35], v[18:19], v[46:47] op_sel_hi:[1,0] neg_lo:[0,1] neg_hi:[0,1]
  v_pk_add_f32 v[36:37], v[20:21], v[46:47] op_sel_hi:[1,0] neg_lo:[0,1] neg_hi:[0,1]
  v_pk_add_f32 v[38:39], v[22:23], v[46:47] op_sel_hi:[1,0] neg_lo:[0,1] neg_hi:[0,1]
  v_pk_add_f32 v[40:41], v[24:25], v[46:47] op_sel_hi:[1,0] neg_lo:[0,1] neg_hi:[0,1]
  v_pk_add_f32 v[42:43], v[26:27], v[46:47] op_sel_hi:[1,0] neg_lo:[0,1] neg_hi:[0,1]
  v_pk_add_f32 v[44:45], v[28:29], v[46:47] op_sel_hi:[1,0] neg_lo:[0,1] neg_hi:[0,1]
  v_pk_mul_f32 v[50:51], v[32:33], v[32:33]
  v_pk_fma_f32 v[50:51], v[34:35], v[34:35], v[50:51]
  v_pk_fma_f32 v[50:51], v[36:37], v[36:37], v[50:51]
  v_pk_fma_f32 v[50:51], v[38:39], v[38:39], v[50:51]
  v_pk_fma_f32 v[50:51], v[40:41], v[40:41], v[50:51]
  v_pk_fma_f32 v[50:51], v[42:43], v[42:43], v[50:51]
  v_pk_fma_f32 v[50:51], v[44:45], v[44:45], v[50:51]
  v_add_f32 v48, v50, v51
  s_nop 1
  v_add_f32_dpp v48, v48, v48 row_ror:8 row_mask:0xf bank_mask:0xf
  s_nop 1
  v_add_f32_dpp v48, v48, v48 row_ror:4 row_mask:0xf bank_mask:0xf
  s_nop 1
  v_add_f32_dpp v48, v48, v48 row_ror:2 row_mask:0xf bank_mask:0xf
  s_nop 1
  v_add_f32_dpp v48, v48, v48 row_ror:1 row_mask:0xf bank_mask:0xf
  v_mov_b32 v49, v48
  s_nop 1
  v_permlane16_swap_b32 v49, v48
  v_add_f32 v48, v48, v49
  v_mul_f32 v48, 0x3b124925, v48
  v_cvt_pk_bf16_f32 v50, v46, v48
  v_lshlrev_b32 v46, 16, v50
  v_and_b32 v48, 0xffff0000, v50
  v_add_f32 v48, 0x3727c5ac, v48
  v_pk_add_f32 v[32:33], v[16:17], v[46:47] op_sel_hi:[1,0] neg_lo:[0,1] neg_hi:[0,1]
  v_cvt_pk_bf16_f32 v48, v48, v48
  v_lshlrev_b32 v48, 16, v48
  v_sqrt_f32 v48, v48
  v_pk_add_f32 v[34:35], v[18:19], v[46:47] op_sel_hi:[1,0] neg_lo:[0,1] neg_hi:[0,1]
  v_pk_add_f32 v[36:37], v[20:21], v[46:47] op_sel_hi:[1,0] neg_lo:[0,1] neg_hi:[0,1]
  v_pk_add_f32 v[38:39], v[22:23], v[46:47] op_sel_hi:[1,0] neg_lo:[0,1] neg_hi:[0,1]
  v_pk_add_f32 v[40:41], v[24:25], v[46:47] op_sel_hi:[1,0] neg_lo:[0,1] neg_hi:[0,1]
  v_pk_add_f32 v[42:43], v[26:27], v[46:47] op_sel_hi:[1,0] neg_lo:[0,1] neg_hi:[0,1]
  v_pk_add_f32 v[44:45], v[28:29], v[46:47] op_sel_hi:[1,0] neg_lo:[0,1] neg_hi:[0,1]
  v_cvt_pk_bf16_f32 v48, v48, v48
  v_lshlrev_b32 v48, 16, v48
  v_rcp_f32 v48, v48
  v_cvt_pk_bf16_f32 v33, v32, v33
  v_cvt_pk_bf16_f32 v35, v34, v35
  v_cvt_pk_bf16_f32 v37, v36, v37
  v_cvt_pk_bf16_f32 v39, v38, v39
  v_cvt_pk_bf16_f32 v41, v40, v41
  v_cvt_pk_bf16_f32 v43, v42, v43
  v_cvt_pk_bf16_f32 v45, v44, v45
  v_lshlrev_b32 v32, 16, v33
  v_and_b32 v33, 0xffff0000, v33
  v_lshlrev_b32 v34, 16, v35
  v_and_b32 v35, 0xffff0000, v35
  v_lshlrev_b32 v36, 16, v37
  v_and_b32 v37, 0xffff0000, v37
  v_lshlrev_b32 v38, 16, v39
  v_and_b32 v39, 0xffff0000, v39
  v_lshlrev_b32 v40, 16, v41
  v_and_b32 v41, 0xffff0000, v41
  v_lshlrev_b32 v42, 16, v43
  v_and_b32 v43, 0xffff0000, v43
  v_lshlrev_b32 v44, 16, v45
  v_and_b32 v45, 0xffff0000, v45
  v_pk_mul_f32 v[32:33], v[32:33], v[48:49] op_sel_hi:[1,0]
  v_pk_mul_f32 v[34:35], v[34:35], v[48:49] op_sel_hi:[1,0]
  v_pk_mul_f32 v[36:37], v[36:37], v[48:49] op_sel_hi:[1,0]
  v_pk_mul_f32 v[38:39], v[38:39], v[48:49] op_sel_hi:[1,0]
  v_pk_mul_f32 v[40:41], v[40:41], v[48:49] op_sel_hi:[1,0]
  v_pk_mul_f32 v[42:43], v[42:43], v[48:49] op_sel_hi:[1,0]
  v_pk_mul_f32 v[44:45], v[44:45], v[48:49] op_sel_hi:[1,0]
  v_cvt_pk_bf16_f32 v8, v32, v33
  v_cvt_pk_bf16_f32 v9, v34, v35
  v_cvt_pk_bf16_f32 v10, v36, v37
  v_cvt_pk_bf16_f32 v11, v38, v39
  v_cvt_pk_bf16_f32 v12, v40, v41
  v_cvt_pk_bf16_f32 v13, v42, v43
  v_cvt_pk_bf16_f32 v14, v44, v45
  ds_write_b32 v5, v8 offset:0
  ds_write_b32 v5, v9 offset:128
  ds_write_b32 v5, v10 offset:256
  ds_write_b32 v5, v11 offset:384
  ds_write_b32 v5, v12 offset:512
  ds_write_b32 v5, v13 offset:640
  ds_write_b32 v5, v14 offset:768
  s_call_b64 s[62:63], L_qc
  s_endpgm
L_w2:
  s_mov_b64 exec, 0
  s_branch L_ca1
L_ca_ret:
  s_mov_b64 exec, -1
  s_waitcnt lgkmcnt(0)
  s_mul_i32 s50, s50, 0x9e3779b1
  s_mul_i32 s51, s51, 0x9e3779b1
  s_add_u32 s50, s50, 0x7f4a7c15
  s_add_u32 s51, s51, 0x7f4a7c15
  s_cmp_eq_u32 s31, 0
  s_cselect_b32 s59, s50, s51
  s_bitcmp0_b32 s2, 3
  s_cselect_b32 s49, s50, s51
  s_cmp_lg_u32 s34, 3
  s_cbranch_scc1 L_w2n
  s_call_b64 s[62:63], L_qc
L_w2n:
  s_mov_b64 exec, 0
  s_branch L_cv2
L_cv_ret:
  s_mov_b64 exec, -1
  s_branch L_hnext
L_w3:
  s_waitcnt lgkmcnt(0)
  s_mul_i32 s50, s50, 0x9e3779b1
  s_mul_i32 s51, s51, 0x9e3779b1
  s_add_u32 s50, s50, 0x7f4a7c15
  s_add_u32 s51, s51, 0x7f4a7c15
  s_cmp_eq_u32 s31, 0
  s_cselect_b32 s59, s50, s51
  s_bitcmp0_b32 s2, 3
  s_cselect_b32 s49, s50, s51
  s_cmp_lg_u32 s34, 3
  s_cbranch_scc1 L_w3n
  s_cmp_ge_u32 s35, 2
  s_cbranch_scc1 L_w3q
  s_lshl_b32 s60, s35, 3
  s_add_u32 s60, s60, s30
  s_lshl_b32 s60, s60, 8
  s_add_u32 s60, s60, 851968
  v_lshl_add_u32 v4, v0, 2, s60
  v_mov_b32 v5, 0
  s_mov_b32 exec_hi, 0
  global_store_dword v4, v5, s[28:29] sc1
L_w3q:
  s_mov_b64 exec, 0
  s_branch L_cq0
L_cq_ret:
  s_mov_b64 exec, -1
  s_waitcnt vmcnt(0) lgkmcnt(0)
  s_call_b64 s[62:63], L_qc
L_w3n:
  s_cmp_lg_u32 s34, 2
  s_cbranch_scc1 L_w3x
  s_getreg_b32 s68, hwreg(HW_REG_XCC_ID, 0, 4)
  s_lshl_b32 s61, s31, 5
  s_add_u32 s61, s61, s35
  s_lshl_b32 s61, s61, 7
  s_add_u32 s61, s61, 958464
  v_mov_b32 v4, s68
  v_mov_b32 v5, s59
  v_mov_b32 v6, s61
  s_mov_b64 exec, 1
  global_store_dwordx2 v6, v[4:5], s[28:29] sc1
L_w3x:
  s_mov_b64 exec, 0
  s_branch L_cx1
L_cx_ret:
  s_mov_b64 exec, -1
  s_mov_b64 exec, 0
  s_branch L_cd2
L_cd_ret:
  s_mov_b64 exec, -1
  s_branch L_hnext
L_w1n:
  s_waitcnt lgkmcnt(0)
  s_mul_i32 s50, s50, 0x9e3779b1
  s_mul_i32 s51, s51, 0x9e3779b1
  s_add_u32 s50, s50, 0x7f4a7c15
  s_add_u32 s51, s51, 0x7f4a7c15
  s_cmp_eq_u32 s31, 0
  s_cselect_b32 s59, s50, s51
  s_bitcmp0_b32 s2, 3
  s_cselect_b32 s49, s50, s51
  s_cmp_eq_u32 s34, 2
  s_cbranch_scc1 L_w1f
  s_cmp_eq_u32 s34, 0
  s_cbranch_scc1 L_fin
  s_mov_b64 exec, 0
  s_branch L_cw2
L_cw_ret:
  s_mov_b64 exec, -1
  s_branch L_tail
L_w1f:
  s_mov_b64 exec, 0
  s_branch L_cf4
L_cf_ret:
  s_mov_b64 exec, -1
L_hnext:
  s_sub_u32 s60, s34, 1
  s_cmp_lt_u32 s60, 2
  s_cbranch_scc0 L_fin
L_tail:
  s_mov_b32 s55, 524288
  s_movk_i32 s58, 0xff
  v_mov_b32 v59, s59
  s_and_b32 s53, s59, 0xff
  s_mov_b32 s47, 0x20000
  v_lshrrev_b32 v7, 2, v60
  v_and_b32 v6, 3, v60
  v_lshlrev_b32 v6, 3, v6
  v_bfe_u32 v8, v0, 3, 2
  v_xor_b32 v8, s3, v8
  v_lshl_add_u32 v8, v8, 5, v6
  s_cmp_eq_u32 s34, 2
  s_cbranch_scc1 L_F
  s_lshl_b32 s60, s33, 15
  s_lshl_b32 s61, s3, 13
  s_add_u32 s60, s60, s61
  s_add_u32 s60, s60, 69632
  v_lshl_add_u32 v1, v0, 4, s60
  s_lshl_b32 s60, s33, 11
  s_lshr_b32 s61, s3, 1
  s_lshl_b32 s61, s61, 4
  s_add_u32 s60, s60, s61
  s_add_u32 s60, s60, 589824
  v_lshrrev_b32 v3, 5, v0
  v_xor_b32 v2, v60, v3
  v_lshl_add_u32 v2, v2, 7, s60
  v_lshl_add_u32 v7, v61, 3, v7
  v_lshl_add_u32 v5, v7, 7, v8
  s_mov_b32 s57, 0x3db8aa3b
  v_bfe_u32 v56, v0, 3, 2
  s_lshl_b32 s60, s3, 2
  v_add_u32 v56, s60, v56
  v_mul_u32_u24 v56, 80, v56
  v_and_b32 v4, 7, v0
  v_lshl_add_u32 v56, v4, 3, v56
  v_lshl_add_u32 v56, v3, 2, v56
  v_add_u32 v56, 131072, v56
  v_mul_u32_u24 v4, 80, v60
  v_lshl_add_u32 v4, v61, 4, v4
  v_add_u32 v4, 131072, v4
  s_mul_i32 s60, s33, 1792
  s_lshl_b32 s61, s35, 8
  s_add_u32 s60, s60, s61
  s_lshl_b32 s61, s3, 6
  s_add_u32 s60, s60, s61
  s_add_u32 s60, s60, 655360
  v_lshl_add_u32 v57, v61, 4, s60
  s_mov_b32 s44, s12
  s_and_b32 s45, s13, 0xffff
  s_mov_b32 s46, 3670016
  s_cmp_eq_u32 s3, 0
  s_cbranch_scc1 L_W1
  s_and_b32 s60, s3, 1
  s_lshl_b32 m0, s60, 15
  s_mul_i32 s65, s60, 229376
  s_mul_i32 s60, s30, 458752
  s_add_u32 s65, s65, s60
  s_lshl_b32 s60, s35, 7
  s_add_u32 s65, s65, s60
  s_mov_b32 s66, 32
  v_and_b32 v12, 7, v0
  v_lshlrev_b32 v12, 4, v12
  v_and_b32 v13, 16, v0
  v_lshlrev_b32 v13, 1, v13
  v_xor_b32 v12, v12, v13
  v_lshrrev_b32 v13, 3, v0
  v_mul_u32_u24 v13, 896, v13
  v_add_u32 v12, v12, v13
  v_xor_b32 v13, 64, v12
  s_barrier
  s_cmp_eq_u32 s3, 1
  s_cbranch_scc1 L_W1
  s_branch L_Wl
L_F:
  s_mov_b32 s80, 0x3fff3fff
  s_mov_b32 s81, 0x3fff3fff
  v_and_b32 v44, 3, v0
  v_lshl_add_u32 v57, v61, 2, v44
  s_lshl_b32 s61, s3, 5
  v_lshl_add_u32 v57, v57, 1, s61
  s_lshl_b32 s60, s35, 7
  v_add_u32 v1, s60, v57
  global_load_short_d16_hi v46, v1, s[18:19]
  v_add_u32 v57, 162560, v57
  v_lshl_add_u32 v42, v44, 2, v61
  s_lshl_b32 s60, s35, 5
  v_lshl_add_u32 v42, v42, 1, s60
  global_load_short_d16_hi v62, v42, s[22:23]
  v_add_u32 v43, 131072, v42
  v_and_b32 v1, 31, v0
  v_min_u32 v1, 27, v1
  v_lshrrev_b32 v2, 5, v0
  s_mul_i32 s61, s3, 224
  v_lshl_add_u32 v58, v1, 3, s61
  v_lshl_add_u32 v58, v2, 2, v58
  s_mul_i32 s60, s31, 896
  v_add_u32 v4, s60, v58
  global_load_dword v52, v4, s[4:5]
  v_add_u32 v42, s60, v42
  v_add_u32 v58, 131072, v58
  v_mad_u32_u24 v4, v61, 14, v60
  v_lshlrev_b32 v4, 3, v4
  v_add_u32 v4, 131072, v4
  s_mul_i32 s60, s31, 14336
  s_mul_i32 s61, s3, 448
  s_add_u32 s60, s60, s61
  s_add_u32 s60, s60, 658944
  v_mul_u32_u24 v2, 1792, v2
  v_lshl_add_u32 v1, v1, 4, v2
  v_add_u32 v1, s60, v1
  v_add_u32 v2, 7168, v1
  v_mad_u32_u24 v5, v61, 56, v7
  v_lshl_add_u32 v5, v5, 7, v8
  v_xor_b32 v9, 64, v5
  v_lshl_add_u32 v7, v61, 3, v7
  v_mul_u32_u24 v3, 928, v7
  v_lshl_add_u32 v3, v61, 7, v3
  s_mul_i32 s60, s3, 224
  s_add_u32 s60, s60, 57344
  v_add3_u32 v3, v3, v6, s60
  v_lshlrev_b32 v53, 4, v61
  v_lshl_add_u32 v56, v60, 6, v53
  v_add_u32 v53, 162560, v53
  s_mul_i32 s60, s31, 28
  s_add_u32 s60, s60, s35
  s_mul_i32 s60, s60, 1792
  s_add_u32 s60, s60, 720896
  v_min_u32 v51, 13, v0
  v_lshl_add_u32 v51, v51, 7, s60
  s_add_u32 s60, s60, s61
  v_add_u32 v56, s60, v56
  s_mul_i32 s60, s31, 50176
  s_lshl_b32 s61, s35, 6
  s_add_u32 s60, s60, s61
  s_add_u32 s60, s60, 720896
  v_lshrrev_b32 v40, 2, v0
  v_min_u32 v41, 11, v40
  v_add_u32 v41, 16, v41
  v_lshl_add_u32 v44, v44, 4, s60
  s_movk_i32 s61, 1792
  v_mad_u32_u24 v40, v40, s61, v44
  v_mad_u32_u24 v41, v41, s61, v44
  v_cmp_gt_u32 vcc, 48, v0
  s_lshl_b32 s60, s31, 7
  v_mov_b32 v45, s60
  v_cndmask_b32 v44, 0, 1.0, vcc
  s_cmp_eq_u32 s3, 2
  s_cselect_b64 s[44:45], s[20:21], s[16:17]
  s_cselect_b32 m0, 57344, 0
  s_movk_i32 s60, 128
  s_cselect_b32 s65, 57344, s60
  s_mul_i32 s65, s65, s35
  s_and_b32 s45, s45, 0xffff
  s_mov_b32 s46, 1605632
  s_movk_i32 s66, 56
  v_and_b32 v12, 7, v0
  v_lshlrev_b32 v12, 4, v12
  v_and_b32 v13, 16, v0
  v_lshlrev_b32 v13, 1, v13
  v_xor_b32 v12, v12, v13
  v_lshrrev_b32 v13, 3, v0
  v_mul_u32_u24 v13, 3584, v13
  v_add_u32 v12, v12, v13
  v_xor_b32 v13, 64, v12
  v_lshlrev_b32 v14, 4, v0
  s_cmp_eq_u32 s3, 0
  s_cbranch_scc1 L_F1
  s_barrier
  s_cmp_eq_u32 s3, 1
  s_cbranch_scc1 L_Fx
  s_cmp_eq_u32 s3, 2
  s_cbranch_scc1 L_Fl2
  s_branch L_Fl
.p2alignl 12, 0xbf810000
L_cq0:
  s_cbranch_execz L_cq_ret
L_qc:
  v_lshrrev_b32 v121, 2, v60
  v_lshl_add_u32 v121, v61, 3, v121
  v_and_b32 v122, 3, v60
  v_lshlrev_b32 v122, 3, v122
  v_bfe_u32 v123, v0, 3, 2
  v_xor_b32 v123, s3, v123
  v_lshl_add_u32 v120, v121, 7, v122
  v_lshl_add_u32 v120, v123, 5, v120
  v_and_b32 v122, 1, v60
  v_cmp_eq_u32 vcc, 0, v122
  v_mul_u32_u24 v121, 896, v122
  v_lshl_add_u32 v121, v61, 4, v121
  v_add_u32 v121, 158464, v121
  v_lshlrev_b32 v122, 14, v122
  v_lshl_add_u32 v122, v61, 4, v122
  s_lshl_b32 s60, s30, 11
  s_lshl_b32 s61, s35, 8
  s_add_u32 s60, s60, s61
  s_lshl_b32 s61, s3, 6
  s_add_u32 s60, s60, s61
  s_add_u32 s60, s60, 4096
  v_add_u32 v122, s60, v122
  v_mov_b32 v13, s50
  v_mov_b32 v15, s51
  v_cndmask_b32 v13, v15, v13, vcc
  v_mov_b32 v15, v13
  s_waitcnt lgkmcnt(0)
  s_barrier
  ds_read_b128 v[64:67], v121 offset:0
  ds_read_b64_tr_b16 v[128:129], v120 offset:0
  ds_read_b64_tr_b16 v[130:131], v120 offset:512
  ds_read_b128 v[68:71], v121 offset:64
  ds_read_b64_tr_b16 v[132:133], v120 offset:4096
  ds_read_b64_tr_b16 v[134:135], v120 offset:4608
  ds_read_b128 v[72:75], v121 offset:128
  ds_read_b64_tr_b16 v[136:137], v120 offset:8192
  ds_read_b64_tr_b16 v[138:139], v120 offset:8704
  ds_read_b128 v[76:79], v121 offset:192
  ds_read_b64_tr_b16 v[140:141], v120 offset:12288
  ds_read_b64_tr_b16 v[142:143], v120 offset:12800
  ds_read_b128 v[80:83], v121 offset:256
  ds_read_b64_tr_b16 v[144:145], v120 offset:16384
  ds_read_b64_tr_b16 v[146:147], v120 offset:16896
  s_waitcnt lgkmcnt(12)
  v_mfma_f32_16x16x32_bf16 v[8:11], v[128:131], v[64:67], 0
  ds_read_b128 v[84:87], v121 offset:320
  ds_read_b64_tr_b16 v[148:149], v120 offset:20480
  ds_read_b64_tr_b16 v[150:151], v120 offset:20992
  s_waitcnt lgkmcnt(12)
  v_mfma_f32_16x16x32_bf16 v[8:11], v[132:135], v[68:71], v[8:11]
  ds_read_b128 v[88:91], v121 offset:384
  ds_read_b64_tr_b16 v[152:153], v120 offset:24576
  ds_read_b64_tr_b16 v[154:155], v120 offset:25088
  s_waitcnt lgkmcnt(12)
  v_mfma_f32_16x16x32_bf16 v[8:11], v[136:139], v[72:75], v[8:11]
  ds_read_b128 v[92:95], v121 offset:448
  ds_read_b64_tr_b16 v[156:157], v120 offset:28672
  ds_read_b64_tr_b16 v[158:159], v120 offset:29184
  s_waitcnt lgkmcnt(12)
  v_mfma_f32_16x16x32_bf16 v[8:11], v[140:143], v[76:79], v[8:11]
  ds_read_b128 v[96:99], v121 offset:512
  ds_read_b64_tr_b16 v[160:161], v120 offset:32768
  ds_read_b64_tr_b16 v[162:163], v120 offset:33280
  s_waitcnt lgkmcnt(12)
  v_mfma_f32_16x16x32_bf16 v[8:11], v[144:147], v[80:83], v[8:11]
  ds_read_b128 v[100:103], v121 offset:576
  ds_read_b64_tr_b16 v[164:165], v120 offset:36864
  ds_read_b64_tr_b16 v[166:167], v120 offset:37376
  s_waitcnt lgkmcnt(12)
  v_mfma_f32_16x16x32_bf16 v[8:11], v[148:151], v[84:87], v[8:11]
  ds_read_b128 v[104:107], v121 offset:640
  ds_read_b64_tr_b16 v[168:169], v120 offset:40960
  ds_read_b64_tr_b16 v[170:171], v120 offset:41472
  s_waitcnt lgkmcnt(12)
  v_mfma_f32_16x16x32_bf16 v[8:11], v[152:155], v[88:91], v[8:11]
  ds_read_b128 v[108:111], v121 offset:704
  ds_read_b64_tr_b16 v[172:173], v120 offset:45056
  ds_read_b64_tr_b16 v[174:175], v120 offset:45568
  s_waitcnt lgkmcnt(12)
  v_mfma_f32_16x16x32_bf16 v[8:11], v[156:159], v[92:95], v[8:11]
  ds_read_b128 v[112:115], v121 offset:768
  ds_read_b64_tr_b16 v[176:177], v120 offset:49152
  ds_read_b64_tr_b16 v[178:179], v120 offset:49664
  s_waitcnt lgkmcnt(12)
  v_mfma_f32_16x16x32_bf16 v[8:11], v[160:163], v[96:99], v[8:11]
  ds_read_b128 v[116:119], v121 offset:832
  ds_read_b64_tr_b16 v[180:181], v120 offset:53248
  ds_read_b64_tr_b16 v[182:183], v120 offset:53760
  s_waitcnt lgkmcnt(12)
  v_mfma_f32_16x16x32_bf16 v[8:11], v[164:167], v[100:103], v[8:11]
  s_waitcnt lgkmcnt(9)
  v_mfma_f32_16x16x32_bf16 v[8:11], v[168:171], v[104:107], v[8:11]
  s_waitcnt lgkmcnt(6)
  v_mfma_f32_16x16x32_bf16 v[8:11], v[172:175], v[108:111], v[8:11]
  s_waitcnt lgkmcnt(3)
  v_mfma_f32_16x16x32_bf16 v[8:11], v[176:179], v[112:115], v[8:11]
  s_waitcnt lgkmcnt(0)
  v_mfma_f32_16x16x32_bf16 v[8:11], v[180:183], v[116:119], v[8:11]
  s_mov_b32 exec_lo, 0x30003
  s_mov_b32 exec_hi, 0x30003
  s_nop 5
  v_cvt_pk_bf16_f32 v12, v8, v9
  v_cvt_pk_bf16_f32 v14, v10, v11
  global_store_dwordx4 v122, v[12:15], s[28:29] sc1
  s_mov_b64 exec, -1
  s_nop 1
  s_setpc_b64 s[62:63]
L_cq_end:
.p2alignl 12, 0xbf810000
L_cw0:
  s_cbranch_execz L_cw_ret
L_Wl:
  s_waitcnt vmcnt(14)
  buffer_load_dwordx4 v12, s[44:47], s65 offen offset:0  lds
  s_add_u32 s65, s65, 6144
  buffer_load_dwordx4 v13, s[44:47], s65 offen offset:1024  lds
  s_add_u32 s65, s65, 6144
  s_waitcnt vmcnt(14)
  buffer_load_dwordx4 v12, s[44:47], s65 offen offset:2048  lds
  s_add_u32 s65, s65, 6144
  buffer_load_dwordx4 v13, s[44:47], s65 offen offset:3072  lds
  s_add_u32 s65, s65, 10240
  s_add_u32 m0, m0, 4096
  s_sub_u32 s66, s66, 4
  s_cmp_lg_u32 s66, 0
  s_cbranch_scc1 L_Wl
  s_waitcnt vmcnt(0)
L_W1:
  s_barrier
  global_load_dwordx3 v[8:10], v2, s[28:29] sc1
  global_load_dwordx4 v[16:19], v1, s[28:29] offset:-4096 sc1
  global_load_dwordx4 v[20:23], v1, s[28:29] offset:-3072 sc1
  global_load_dwordx4 v[24:27], v1, s[28:29] offset:-2048 sc1
  global_load_dwordx4 v[28:31], v1, s[28:29] offset:-1024 sc1
  global_load_dwordx4 v[32:35], v1, s[28:29] offset:0 sc1
  global_load_dwordx4 v[36:39], v1, s[28:29] offset:1024 sc1
  global_load_dwordx4 v[40:43], v1, s[28:29] offset:2048 sc1
  global_load_dwordx4 v[44:47], v1, s[28:29] offset:3072 sc1
  ds_read_b64_tr_b16 v[128:129], v5 offset:0
  ds_read_b64_tr_b16 v[130:131], v5 offset:512
  ds_read_b64_tr_b16 v[132:133], v5 offset:4096
  ds_read_b64_tr_b16 v[134:135], v5 offset:4608
  ds_read_b64_tr_b16 v[136:137], v5 offset:8192
  ds_read_b64_tr_b16 v[138:139], v5 offset:8704
  ds_read_b64_tr_b16 v[140:141], v5 offset:12288
  ds_read_b64_tr_b16 v[142:143], v5 offset:12800
  ds_read_b64_tr_b16 v[144:145], v5 offset:16384
  ds_read_b64_tr_b16 v[146:147], v5 offset:16896
  ds_read_b64_tr_b16 v[148:149], v5 offset:20480
  ds_read_b64_tr_b16 v[150:151], v5 offset:20992
  ds_read_b64_tr_b16 v[152:153], v5 offset:24576
  ds_read_b64_tr_b16 v[154:155], v5 offset:25088
  ds_read_b64_tr_b16 v[156:157], v5 offset:28672
  ds_read_b64_tr_b16 v[158:159], v5 offset:29184
  ds_read_b64_tr_b16 v[160:161], v5 offset:32768
  ds_read_b64_tr_b16 v[162:163], v5 offset:33280
  ds_read_b64_tr_b16 v[164:165], v5 offset:36864
  ds_read_b64_tr_b16 v[166:167], v5 offset:37376
  ds_read_b64_tr_b16 v[168:169], v5 offset:40960
  ds_read_b64_tr_b16 v[170:171], v5 offset:41472
  ds_read_b64_tr_b16 v[172:173], v5 offset:45056
  ds_read_b64_tr_b16 v[174:175], v5 offset:45568
  ds_read_b64_tr_b16 v[176:177], v5 offset:49152
  ds_read_b64_tr_b16 v[178:179], v5 offset:49664
  ds_read_b64_tr_b16 v[180:181], v5 offset:53248
  ds_read_b64_tr_b16 v[182:183], v5 offset:53760
  ds_read_b64_tr_b16 v[184:185], v5 offset:57344
  ds_read_b64_tr_b16 v[186:187], v5 offset:57856
  ds_read_b64_tr_b16 v[188:189], v5 offset:61440
  ds_read_b64_tr_b16 v[190:191], v5 offset:61952
  s_waitcnt vmcnt(8)
  s_branch L_wchk
L_cw1:
  s_cbranch_execz L_cw0
L_wpoll:
  global_load_dwordx3 v[8:10], v2, s[28:29] sc1
  v_cmp_ne_u32_sdwa vcc, v16, v59 src0_sel:BYTE_0 src1_sel:BYTE_0
  s_cbranch_vccz L_wskip0
  global_load_dwordx4 v[16:19], v1, s[28:29] offset:-4096 sc1
L_wskip0:
  v_cmp_ne_u32_sdwa vcc, v20, v59 src0_sel:BYTE_0 src1_sel:BYTE_0
  s_cbranch_vccz L_wskip1
  global_load_dwordx4 v[20:23], v1, s[28:29] offset:-3072 sc1
L_wskip1:
  v_cmp_ne_u32_sdwa vcc, v24, v59 src0_sel:BYTE_0 src1_sel:BYTE_0
  s_cbranch_vccz L_wskip2
  global_load_dwordx4 v[24:27], v1, s[28:29] offset:-2048 sc1
L_wskip2:
  v_cmp_ne_u32_sdwa vcc, v28, v59 src0_sel:BYTE_0 src1_sel:BYTE_0
  s_cbranch_vccz L_wskip3
  global_load_dwordx4 v[28:31], v1, s[28:29] offset:-1024 sc1
L_wskip3:
  v_cmp_ne_u32_sdwa vcc, v32, v59 src0_sel:BYTE_0 src1_sel:BYTE_0
  s_cbranch_vccz L_wskip4
  global_load_dwordx4 v[32:35], v1, s[28:29] offset:0 sc1
L_wskip4:
  v_cmp_ne_u32_sdwa vcc, v36, v59 src0_sel:BYTE_0 src1_sel:BYTE_0
  s_cbranch_vccz L_wskip5
  global_load_dwordx4 v[36:39], v1, s[28:29] offset:1024 sc1
L_wskip5:
  v_cmp_ne_u32_sdwa vcc, v40, v59 src0_sel:BYTE_0 src1_sel:BYTE_0
  s_cbranch_vccz L_wskip6
  global_load_dwordx4 v[40:43], v1, s[28:29] offset:2048 sc1
L_wskip6:
  v_cmp_ne_u32_sdwa vcc, v44, v59 src0_sel:BYTE_0 src1_sel:BYTE_0
  s_cbranch_vccz L_wskip7
  global_load_dwordx4 v[44:47], v1, s[28:29] offset:3072 sc1
L_wskip7:
  s_sub_u32 s55, s55, 1
  s_cbranch_scc1 L_wgot
  s_waitcnt vmcnt(0)
L_wchk:
  v_max_f32_dpp v11, v8, v8 row_ror:8 row_mask:0xf bank_mask:0xf
  v_xor_b32 v58, v10, v59
  s_nop 0
  v_max_f32_dpp v11, v11, v11 row_ror:4 row_mask:0xf bank_mask:0xf
  s_nop 1
  v_max_f32_dpp v11, v11, v11 row_ror:2 row_mask:0xf bank_mask:0xf
  s_nop 1
  v_max_f32_dpp v11, v11, v11 row_ror:1 row_mask:0xf bank_mask:0xf
  v_sub_f32 v11, v8, v11
  v_mul_f32 v11, s57, v11
  v_exp_f32 v11, v11
  s_nop 0
  v_mul_f32 v6, v11, v9
  s_nop 1
  v_add_f32_dpp v6, v6, v6 row_ror:8 row_mask:0xf bank_mask:0xf
  s_nop 1
  v_add_f32_dpp v6, v6, v6 row_ror:4 row_mask:0xf bank_mask:0xf
  s_nop 1
  v_add_f32_dpp v6, v6, v6 row_ror:2 row_mask:0xf bank_mask:0xf
  s_nop 1
  v_add_f32_dpp v6, v6, v6 row_ror:1 row_mask:0xf bank_mask:0xf
  v_rcp_f32 v6, v6
  s_waitcnt vmcnt(7)
  v_xor_b32 v48, s53, v16
  v_mul_f32_dpp v13, v11, v17 row_newbcast:0 row_mask:0xf bank_mask:0xf
  v_mul_f32_dpp v14, v11, v18 row_newbcast:0 row_mask:0xf bank_mask:0xf
  v_mul_f32_dpp v15, v11, v19 row_newbcast:0 row_mask:0xf bank_mask:0xf
  v_mul_f32_dpp v12, v11, v48 row_newbcast:0 row_mask:0xf bank_mask:0xf
  v_and_or_b32 v58, v48, s58, v58
  s_waitcnt vmcnt(6)
  v_xor_b32 v48, s53, v20
  v_fmac_f32_dpp v13, v11, v21 row_newbcast:2 row_mask:0xf bank_mask:0xf
  v_fmac_f32_dpp v14, v11, v22 row_newbcast:2 row_mask:0xf bank_mask:0xf
  v_fmac_f32_dpp v15, v11, v23 row_newbcast:2 row_mask:0xf bank_mask:0xf
  v_fmac_f32_dpp v12, v11, v48 row_newbcast:2 row_mask:0xf bank_mask:0xf
  v_and_or_b32 v58, v48, s58, v58
  s_waitcnt vmcnt(5)
  v_xor_b32 v48, s53, v24
  v_fmac_f32_dpp v13, v11, v25 row_newbcast:4 row_mask:0xf bank_mask:0xf
  v_fmac_f32_dpp v14, v11, v26 row_newbcast:4 row_mask:0xf bank_mask:0xf
  v_fmac_f32_dpp v15, v11, v27 row_newbcast:4 row_mask:0xf bank_mask:0xf
  v_fmac_f32_dpp v12, v11, v48 row_newbcast:4 row_mask:0xf bank_mask:0xf
  v_and_or_b32 v58, v48, s58, v58
  s_waitcnt vmcnt(4)
  v_xor_b32 v48, s53, v28
  v_fmac_f32_dpp v13, v11, v29 row_newbcast:6 row_mask:0xf bank_mask:0xf
  v_fmac_f32_dpp v14, v11, v30 row_newbcast:6 row_mask:0xf bank_mask:0xf
  v_fmac_f32_dpp v15, v11, v31 row_newbcast:6 row_mask:0xf bank_mask:0xf
  v_fmac_f32_dpp v12, v11, v48 row_newbcast:6 row_mask:0xf bank_mask:0xf
  v_and_or_b32 v58, v48, s58, v58
  s_waitcnt vmcnt(3)
  v_xor_b32 v48, s53, v32
  v_fmac_f32_dpp v13, v11, v33 row_newbcast:8 row_mask:0xf bank_mask:0xf
  v_fmac_f32_dpp v14, v11, v34 row_newbcast:8 row_mask:0xf bank_mask:0xf
  v_fmac_f32_dpp v15, v11, v35 row_newbcast:8 row_mask:0xf bank_mask:0xf
  v_fmac_f32_dpp v12, v11, v48 row_newbcast:8 row_mask:0xf bank_mask:0xf
  v_and_or_b32 v58, v48, s58, v58
  s_waitcnt vmcnt(2)
  v_xor_b32 v48, s53, v36
  v_fmac_f32_dpp v13, v11, v37 row_newbcast:10 row_mask:0xf bank_mask:0xf
  v_fmac_f32_dpp v14, v11, v38 row_newbcast:10 row_mask:0xf bank_mask:0xf
  v_fmac_f32_dpp v15, v11, v39 row_newbcast:10 row_mask:0xf bank_mask:0xf
  v_fmac_f32_dpp v12, v11, v48 row_newbcast:10 row_mask:0xf bank_mask:0xf
  v_and_or_b32 v58, v48, s58, v58
  s_waitcnt vmcnt(1)
  v_xor_b32 v48, s53, v40
  v_fmac_f32_dpp v13, v11, v41 row_newbcast:12 row_mask:0xf bank_mask:0xf
  v_fmac_f32_dpp v14, v11, v42 row_newbcast:12 row_mask:0xf bank_mask:0xf
  v_fmac_f32_dpp v15, v11, v43 row_newbcast:12 row_mask:0xf bank_mask:0xf
  v_fmac_f32_dpp v12, v11, v48 row_newbcast:12 row_mask:0xf bank_mask:0xf
  v_and_or_b32 v58, v48, s58, v58
  s_waitcnt vmcnt(0)
  v_xor_b32 v48, s53, v44
  v_fmac_f32_dpp v13, v11, v45 row_newbcast:14 row_mask:0xf bank_mask:0xf
  v_fmac_f32_dpp v14, v11, v46 row_newbcast:14 row_mask:0xf bank_mask:0xf
  v_fmac_f32_dpp v15, v11, v47 row_newbcast:14 row_mask:0xf bank_mask:0xf
  v_fmac_f32_dpp v12, v11, v48 row_newbcast:14 row_mask:0xf bank_mask:0xf
  v_and_or_b32 v58, v48, s58, v58
  v_cmp_ne_u32 vcc, 0, v58
  v_permlane32_swap_b32 v13, v15
  v_permlane32_swap_b32 v12, v14
  s_cbranch_vccnz L_wpoll
L_wgot:
  v_pk_add_f32 v[12:13], v[12:13], v[14:15]
  v_pk_mul_f32 v[12:13], v[12:13], v[6:7] op_sel_hi:[1,0]
  v_cvt_pk_bf16_f32 v12, v12, v13
  ds_write_b32 v56, v12
  s_waitcnt lgkmcnt(0)
  s_barrier
  ds_read_b128 v[20:23], v4
L_cw2:
  s_cbranch_execz L_cw1
  s_waitcnt lgkmcnt(0)
  v_mov_b64_dpp v[64:65], v[20:21] row_newbcast:0 row_mask:0xf bank_mask:0xf
  v_mov_b64_dpp v[66:67], v[22:23] row_newbcast:0 row_mask:0xf bank_mask:0xf
  v_mov_b64_dpp v[68:69], v[20:21] row_newbcast:1 row_mask:0xf bank_mask:0xf
  v_mov_b64_dpp v[70:71], v[22:23] row_newbcast:1 row_mask:0xf bank_mask:0xf
  v_mfma_f32_16x16x32_bf16 v[8:11], v[128:131], v[64:67], 0
  v_mov_b64_dpp v[72:73], v[20:21] row_newbcast:2 row_mask:0xf bank_mask:0xf
  v_mov_b64_dpp v[74:75], v[22:23] row_newbcast:2 row_mask:0xf bank_mask:0xf
  v_mfma_f32_16x16x32_bf16 v[8:11], v[132:135], v[68:71], v[8:11]
  v_mov_b64_dpp v[64:65], v[20:21] row_newbcast:3 row_mask:0xf bank_mask:0xf
  v_mov_b64_dpp v[66:67], v[22:23] row_newbcast:3 row_mask:0xf bank_mask:0xf
  v_mfma_f32_16x16x32_bf16 v[8:11], v[136:139], v[72:75], v[8:11]
  v_mov_b64_dpp v[68:69], v[20:21] row_newbcast:4 row_mask:0xf bank_mask:0xf
  v_mov_b64_dpp v[70:71], v[22:23] row_newbcast:4 row_mask:0xf bank_mask:0xf
  v_mfma_f32_16x16x32_bf16 v[8:11], v[140:143], v[64:67], v[8:11]
  v_mov_b64_dpp v[72:73], v[20:21] row_newbcast:5 row_mask:0xf bank_mask:0xf
  v_mov_b64_dpp v[74:75], v[22:23] row_newbcast:5 row_mask:0xf bank_mask:0xf
  v_mfma_f32_16x16x32_bf16 v[8:11], v[144:147], v[68:71], v[8:11]
  v_mov_b64_dpp v[64:65], v[20:21] row_newbcast:6 row_mask:0xf bank_mask:0xf
  v_mov_b64_dpp v[66:67], v[22:23] row_newbcast:6 row_mask:0xf bank_mask:0xf
  v_mfma_f32_16x16x32_bf16 v[8:11], v[148:151], v[72:75], v[8:11]
  v_mov_b64_dpp v[68:69], v[20:21] row_newbcast:7 row_mask:0xf bank_mask:0xf
  v_mov_b64_dpp v[70:71], v[22:23] row_newbcast:7 row_mask:0xf bank_mask:0xf
  v_mfma_f32_16x16x32_bf16 v[8:11], v[152:155], v[64:67], v[8:11]
  v_mov_b64_dpp v[72:73], v[20:21] row_newbcast:8 row_mask:0xf bank_mask:0xf
  v_mov_b64_dpp v[74:75], v[22:23] row_newbcast:8 row_mask:0xf bank_mask:0xf
  v_mfma_f32_16x16x32_bf16 v[8:11], v[156:159], v[68:71], v[8:11]
  v_mov_b64_dpp v[64:65], v[20:21] row_newbcast:9 row_mask:0xf bank_mask:0xf
  v_mov_b64_dpp v[66:67], v[22:23] row_newbcast:9 row_mask:0xf bank_mask:0xf
  v_mfma_f32_16x16x32_bf16 v[8:11], v[160:163], v[72:75], v[8:11]
  v_mov_b64_dpp v[68:69], v[20:21] row_newbcast:10 row_mask:0xf bank_mask:0xf
  v_mov_b64_dpp v[70:71], v[22:23] row_newbcast:10 row_mask:0xf bank_mask:0xf
  v_mfma_f32_16x16x32_bf16 v[8:11], v[164:167], v[64:67], v[8:11]
  v_mov_b64_dpp v[72:73], v[20:21] row_newbcast:11 row_mask:0xf bank_mask:0xf
  v_mov_b64_dpp v[74:75], v[22:23] row_newbcast:11 row_mask:0xf bank_mask:0xf
  v_mfma_f32_16x16x32_bf16 v[8:11], v[168:171], v[68:71], v[8:11]
  v_mov_b64_dpp v[64:65], v[20:21] row_newbcast:12 row_mask:0xf bank_mask:0xf
  v_mov_b64_dpp v[66:67], v[22:23] row_newbcast:12 row_mask:0xf bank_mask:0xf
  v_mfma_f32_16x16x32_bf16 v[8:11], v[172:175], v[72:75], v[8:11]
  v_mov_b64_dpp v[68:69], v[20:21] row_newbcast:13 row_mask:0xf bank_mask:0xf
  v_mov_b64_dpp v[70:71], v[22:23] row_newbcast:13 row_mask:0xf bank_mask:0xf
  v_mfma_f32_16x16x32_bf16 v[8:11], v[176:179], v[64:67], v[8:11]
  v_mov_b64_dpp v[72:73], v[20:21] row_newbcast:14 row_mask:0xf bank_mask:0xf
  v_mov_b64_dpp v[74:75], v[22:23] row_newbcast:14 row_mask:0xf bank_mask:0xf
  v_mfma_f32_16x16x32_bf16 v[8:11], v[180:183], v[68:71], v[8:11]
  v_mov_b64_dpp v[64:65], v[20:21] row_newbcast:15 row_mask:0xf bank_mask:0xf
  v_mov_b64_dpp v[66:67], v[22:23] row_newbcast:15 row_mask:0xf bank_mask:0xf
  v_mfma_f32_16x16x32_bf16 v[8:11], v[184:187], v[72:75], v[8:11]
  s_nop 0
  v_mfma_f32_16x16x32_bf16 v[8:11], v[188:191], v[64:67], v[8:11]
  s_mov_b32 exec_lo, 0x10001
  s_mov_b32 exec_hi, 0x10001
  s_nop 5
  v_bfi_b32 v8, s58, v59, v8
  global_store_dwordx4 v57, v[8:11], s[28:29] sc1
  s_endpgm
L_cw_end:
.p2alignl 12, 0xbf810000
L_cf0:
  s_cbranch_execz L_cf_ret
L_Fl:
  s_waitcnt vmcnt(14)
  buffer_load_dwordx4 v12, s[44:47], s65 offen offset:0  lds
  s_add_u32 s65, s65, 27648
  buffer_load_dwordx4 v13, s[44:47], s65 offen offset:1024  lds
  s_add_u32 s65, s65, 27648
  s_waitcnt vmcnt(14)
  buffer_load_dwordx4 v12, s[44:47], s65 offen offset:2048  lds
  s_add_u32 s65, s65, 27648
  buffer_load_dwordx4 v13, s[44:47], s65 offen offset:3072  lds
  s_add_u32 s65, s65, 31744
  s_add_u32 m0, m0, 4096
  s_waitcnt vmcnt(14)
  buffer_load_dwordx4 v12, s[44:47], s65 offen offset:0  lds
  s_add_u32 s65, s65, 27648
  buffer_load_dwordx4 v13, s[44:47], s65 offen offset:1024  lds
  s_add_u32 s65, s65, 27648
  s_waitcnt vmcnt(14)
  buffer_load_dwordx4 v12, s[44:47], s65 offen offset:2048  lds
  s_add_u32 s65, s65, 27648
  buffer_load_dwordx4 v13, s[44:47], s65 offen offset:3072  lds
  s_add_u32 s65, s65, 31744
  s_add_u32 m0, m0, 4096
  s_sub_u32 s66, s66, 8
  s_cmp_lg_u32 s66, 0
  s_cbranch_scc1 L_Fl
  s_branch L_F1
L_Fx:
  s_getreg_b32 s68, hwreg(HW_REG_XCC_ID, 0, 4)
  s_lshl_b32 s64, s31, 12
  s_add_u32 s64, s64, 958464
  v_min_u32 v12, 27, v0
  v_lshl_add_u32 v12, v12, 7, s64
L_xpoll:
  global_load_dwordx2 v[14:15], v12, s[28:29] sc1
  s_sub_u32 s55, s55, 1
  s_cbranch_scc1 L_xgot
  s_waitcnt vmcnt(0)
  v_cmp_ne_u32 vcc, s59, v15
  s_cbranch_vccnz L_xpoll
L_xgot:
  s_waitcnt vmcnt(0)
  v_cmp_ne_u32 vcc, s68, v14
  s_mov_b32 s55, 524288
  s_cmp_eq_u64 vcc, 0
  s_cselect_b32 s66, 1, 0
  v_mov_b32 v12, s66
  v_mov_b32 v13, 161536
  ds_write_b32 v13, v12
  s_branch L_F1
L_Fl2:
  s_mov_b32 exec_hi, 0x00ffffff
L_Fl3:
  s_waitcnt vmcnt(16)
  buffer_load_dwordx4 v14, s[44:47], s65 offen lds
  s_add_u32 m0, m0, 928
  s_add_u32 s65, s65, 896
  buffer_load_dwordx4 v14, s[44:47], s65 offen lds
  s_add_u32 m0, m0, 928
  s_add_u32 s65, s65, 896
  s_waitcnt vmcnt(16)
  buffer_load_dwordx4 v14, s[44:47], s65 offen lds
  s_add_u32 m0, m0, 928
  s_add_u32 s65, s65, 896
  buffer_load_dwordx4 v14, s[44:47], s65 offen lds
  s_add_u32 m0, m0, 928
  s_add_u32 s65, s65, 896
  s_waitcnt vmcnt(16)
  buffer_load_dwordx4 v14, s[44:47], s65 offen lds
  s_add_u32 m0, m0, 928
  s_add_u32 s65, s65, 896
  buffer_load_dwordx4 v14, s[44:47], s65 offen lds
  s_add_u32 m0, m0, 928
  s_add_u32 s65, s65, 896
  s_waitcnt vmcnt(16)
  buffer_load_dwordx4 v14, s[44:47], s65 offen lds
  s_add_u32 m0, m0, 928
  s_add_u32 s65, s65, 896
  buffer_load_dwordx4 v14, s[44:47], s65 offen lds
  s_add_u32 m0, m0, 1056
  s_add_u32 s65, s65, 896
  s_sub_u32 s66, s66, 7
  s_cmp_lg_u32 s66, 0
  s_cbranch_scc1 L_Fl3
  s_mov_b64 exec, -1
  global_load_dword v51, v51, s[28:29] sc1
L_F1:
  v_mov_b32 v50, 161536
  v_mov_b32 v32, 0
  v_mov_b32 v34, 0
  v_and_b32 v47, 3, v0
  v_cmp_eq_u32 s[4:5], 1, v47
  v_cmp_eq_u32 s[6:7], 2, v47
  v_cmp_eq_u32 s[8:9], 3, v47
  v_cmp_eq_u32 s[10:11], 1, v60
  v_cmp_eq_u32 s[12:13], 2, v60
  v_cmp_eq_u32 s[14:15], 3, v60
  v_cmp_eq_u32 s[16:17], 4, v60
  v_cmp_eq_u32 s[18:19], 5, v60
  v_cmp_eq_u32 s[20:21], 6, v60
  s_waitcnt vmcnt(0) lgkmcnt(0)
  s_barrier
L_cf1:
  s_cbranch_execz L_cf0
  ds_read_b64_tr_b16 v[128:129], v5 offset:0
  ds_read_b64_tr_b16 v[130:131], v5 offset:28672
  ds_read_b64_tr_b16 v[132:133], v5 offset:512
  ds_read_b64_tr_b16 v[134:135], v5 offset:29184
  ds_read_b64_tr_b16 v[136:137], v9 offset:1024
  ds_read_b64_tr_b16 v[138:139], v9 offset:29696
  ds_read_b64_tr_b16 v[140:141], v9 offset:1536
  ds_read_b64_tr_b16 v[142:143], v9 offset:30208
  ds_read_b64_tr_b16 v[144:145], v5 offset:2048
  ds_read_b64_tr_b16 v[146:147], v5 offset:30720
  ds_read_b64_tr_b16 v[148:149], v5 offset:2560
  ds_read_b64_tr_b16 v[150:151], v5 offset:31232
  ds_read_b64_tr_b16 v[152:153], v9 offset:3072
  ds_read_b64_tr_b16 v[154:155], v9 offset:31744
  ds_read_b64_tr_b16 v[156:157], v9 offset:3584
  ds_read_b64_tr_b16 v[158:159], v9 offset:32256
  ds_read_b64_tr_b16 v[160:161], v5 offset:4096
  ds_read_b64_tr_b16 v[162:163], v5 offset:32768
  ds_read_b64_tr_b16 v[164:165], v5 offset:4608
  ds_read_b64_tr_b16 v[166:167], v5 offset:33280
  global_load_dwordx4 v[64:67], v1, s[28:29] offset:-3584 sc1
  global_load_dwordx4 v[68:71], v1, s[28:29] offset:0 sc1
  global_load_dwordx4 v[72:75], v2, s[28:29] offset:-3584 sc1
  global_load_dwordx4 v[76:79], v2, s[28:29] offset:0 sc1
  ds_read_b64_tr_b16 v[168:169], v9 offset:5120
  ds_read_b64_tr_b16 v[170:171], v9 offset:33792
  ds_read_b64_tr_b16 v[172:173], v9 offset:5632
  ds_read_b64_tr_b16 v[174:175], v9 offset:34304
  ds_read_b64_tr_b16 v[176:177], v5 offset:6144
  ds_read_b64_tr_b16 v[178:179], v5 offset:34816
  ds_read_b64_tr_b16 v[180:181], v5 offset:6656
  ds_read_b64_tr_b16 v[182:183], v5 offset:35328
  ds_read_b64_tr_b16 v[192:193], v3 offset:0
  ds_read_b64_tr_b16 v[194:195], v3 offset:3712
  ds_read_b64_tr_b16 v[196:197], v3 offset:30208
  ds_read_b64_tr_b16 v[198:199], v3 offset:33920
  ds_read_b64_tr_b16 v[200:201], v3 offset:32
  ds_read_b64_tr_b16 v[202:203], v3 offset:3744
  ds_read_b64_tr_b16 v[204:205], v3 offset:30240
  ds_read_b64_tr_b16 v[206:207], v3 offset:33952
  ds_read_b64_tr_b16 v[208:209], v3 offset:64
  ds_read_b64_tr_b16 v[210:211], v3 offset:3776
  ds_read_b64_tr_b16 v[212:213], v3 offset:30272
  ds_read_b64_tr_b16 v[214:215], v3 offset:33984
  ds_read_b64_tr_b16 v[216:217], v3 offset:96
  ds_read_b64_tr_b16 v[218:219], v3 offset:3808
  ds_read_b64_tr_b16 v[220:221], v3 offset:30304
  ds_read_b64_tr_b16 v[222:223], v3 offset:34016
  ds_read_b64_tr_b16 v[224:225], v3 offset:128
  ds_read_b64_tr_b16 v[226:227], v3 offset:3840
  ds_read_b64_tr_b16 v[228:229], v3 offset:30336
  ds_read_b64_tr_b16 v[230:231], v3 offset:34048
  ds_read_b64_tr_b16 v[232:233], v3 offset:160
  ds_read_b64_tr_b16 v[234:235], v3 offset:3872
  ds_read_b64_tr_b16 v[236:237], v3 offset:30368
  ds_read_b64_tr_b16 v[238:239], v3 offset:34080
  ds_read_b64_tr_b16 v[240:241], v3 offset:192
  ds_read_b64_tr_b16 v[242:243], v3 offset:3904
  ds_read_b64_tr_b16 v[244:245], v3 offset:30400
  ds_read_b64_tr_b16 v[246:247], v3 offset:34112
  ds_read_b32 v50, v50
  v_and_b32 v46, 0xffff0000, v46
  v_and_b32 v62, 0xffff0000, v62
  v_lshlrev_b32 v54, 16, v52
  v_and_b32 v55, 0xffff0000, v52
  s_branch L_hchk
L_cf2:
  s_cbranch_execz L_cf1
L_hpoll:
  global_load_dwordx4 v[64:67], v1, s[28:29] offset:-3584 sc1
  global_load_dwordx4 v[68:71], v1, s[28:29] offset:0 sc1
  global_load_dwordx4 v[72:75], v2, s[28:29] offset:-3584 sc1
  global_load_dwordx4 v[76:79], v2, s[28:29] offset:0 sc1
  s_sub_u32 s55, s55, 1
  s_cbranch_scc1 L_hgot
L_hchk:
  s_waitcnt vmcnt(2)
  v_xor_b32 v64, s53, v64
  v_xor_b32 v68, s53, v68
  v_pk_add_f32 v[82:83], v[66:67], v[70:71]
  v_pk_add_f32 v[80:81], v[64:65], v[68:69]
  s_waitcnt vmcnt(1)
  v_xor_b32 v72, s53, v72
  v_pk_add_f32 v[82:83], v[82:83], v[74:75]
  v_pk_add_f32 v[80:81], v[80:81], v[72:73]
  v_or3_b32 v16, v64, v68, v72
  s_waitcnt vmcnt(0)
  v_xor_b32 v76, s53, v76
  v_pk_add_f32 v[82:83], v[82:83], v[78:79]
  v_pk_add_f32 v[80:81], v[80:81], v[76:77]
  v_bitop3_b32 v16, v16, s58, v76 bitop3:0xc8
  v_cmp_ne_u32 vcc, 0, v16
  v_permlane32_swap_b32 v80, v82
  v_permlane32_swap_b32 v81, v83
  s_cbranch_vccnz L_hpoll
L_hgot:
  v_pk_add_f32 v[80:81], v[80:81], v[82:83]
  v_cvt_pk_bf16_f32 v81, v80, v81
  v_lshlrev_b32 v80, 16, v81
  v_and_b32 v81, 0xffff0000, v81
  v_pk_add_f32 v[80:81], v[80:81], v[54:55]
  v_cvt_pk_bf16_f32 v80, v80, v81
  ds_write_b32 v58, v80
  s_waitcnt lgkmcnt(0)
  s_barrier
  ds_read_b64 v[16:17], v4
  ds_read_b64 v[18:19], v4 offset:448
  v_readfirstlane_b32 s82, v50
L_cf3:
  s_cbranch_execz L_cf2
  s_waitcnt lgkmcnt(1)
  v_lshlrev_b32 v8, 16, v16
  v_and_b32 v9, 0xffff0000, v16
  v_lshlrev_b32 v10, 16, v17
  v_and_b32 v11, 0xffff0000, v17
  s_waitcnt lgkmcnt(0)
  v_lshlrev_b32 v12, 16, v18
  v_and_b32 v13, 0xffff0000, v18
  v_lshlrev_b32 v14, 16, v19
  v_and_b32 v15, 0xffff0000, v19
  v_readfirstlane_b32 s60, v8
  s_mov_b64 exec, s[80:81]
  s_mov_b32 s61, s60
  v_pk_add_f32 v[24:25], v[8:9], s[60:61] neg_lo:[0,1] neg_hi:[0,1]
  v_pk_add_f32 v[26:27], v[10:11], s[60:61] neg_lo:[0,1] neg_hi:[0,1]
  v_pk_add_f32 v[28:29], v[12:13], s[60:61] neg_lo:[0,1] neg_hi:[0,1]
  v_pk_add_f32 v[30:31], v[14:15], s[60:61] neg_lo:[0,1] neg_hi:[0,1]
  v_pk_add_f32 v[36:37], v[24:25], v[26:27]
  v_pk_mul_f32 v[38:39], v[24:25], v[24:25]
  v_pk_fma_f32 v[38:39], v[26:27], v[26:27], v[38:39]
  v_pk_add_f32 v[36:37], v[36:37], v[28:29]
  v_pk_fma_f32 v[38:39], v[28:29], v[28:29], v[38:39]
  v_pk_add_f32 v[36:37], v[36:37], v[30:31]
  v_pk_fma_f32 v[38:39], v[30:31], v[30:31], v[38:39]
  v_add_f32 v32, v36, v37
  v_add_f32 v34, v38, v39
  s_mov_b64 exec, -1
  v_add_f32_dpp v32, v32, v32 row_ror:8 row_mask:0xf bank_mask:0xf
  v_add_f32_dpp v34, v34, v34 row_ror:8 row_mask:0xf bank_mask:0xf
  s_nop 0
  v_add_f32_dpp v32, v32, v32 row_ror:4 row_mask:0xf bank_mask:0xf
  v_add_f32_dpp v34, v34, v34 row_ror:4 row_mask:0xf bank_mask:0xf
  s_nop 0
  v_add_f32_dpp v32, v32, v32 row_ror:2 row_mask:0xf bank_mask:0xf
  v_add_f32_dpp v34, v34, v34 row_ror:2 row_mask:0xf bank_mask:0xf
  s_nop 0
  v_add_f32_dpp v32, v32, v32 row_ror:1 row_mask:0xf bank_mask:0xf
  v_add_f32_dpp v34, v34, v34 row_ror:1 row_mask:0xf bank_mask:0xf
  s_nop 1
  v_permlane32_swap_b32 v32, v34
  v_add_f32 v32, v32, v34
  v_mov_b32 v34, v32
  s_nop 1
  v_permlane16_swap_b32 v34, v32
  v_add_f32 v32, v32, v34
  v_mul_f32 v32, 0x3b124925, v32
  v_mov_b32 v34, v32
  s_nop 1
  v_permlane32_swap_b32 v32, v34
  v_fma_f32 v34, -v32, v32, v34
  v_add_f32 v32, s60, v32
  v_max_f32 v34, 0, v34
  v_cvt_pk_bf16_f32 v36, v32, v34
  v_lshlrev_b32 v32, 16, v36
  v_and_b32 v34, 0xffff0000, v36
  v_add_f32 v34, 0x3727c5ac, v34
  v_pk_add_f32 v[24:25], v[8:9], v[32:33] op_sel_hi:[1,0] neg_lo:[0,1] neg_hi:[0,1]
  v_cvt_pk_bf16_f32 v34, v34, v34
  v_lshlrev_b32 v34, 16, v34
  v_sqrt_f32 v34, v34
  v_pk_add_f32 v[26:27], v[10:11], v[32:33] op_sel_hi:[1,0] neg_lo:[0,1] neg_hi:[0,1]
  v_pk_add_f32 v[28:29], v[12:13], v[32:33] op_sel_hi:[1,0] neg_lo:[0,1] neg_hi:[0,1]
  v_pk_add_f32 v[30:31], v[14:15], v[32:33] op_sel_hi:[1,0] neg_lo:[0,1] neg_hi:[0,1]
  v_cvt_pk_bf16_f32 v34, v34, v34
  v_lshlrev_b32 v34, 16, v34
  v_rcp_f32 v34, v34
  v_cvt_pk_bf16_f32 v25, v24, v25
  v_cvt_pk_bf16_f32 v27, v26, v27
  v_cvt_pk_bf16_f32 v29, v28, v29
  v_cvt_pk_bf16_f32 v31, v30, v31
  v_lshlrev_b32 v24, 16, v25
  v_and_b32 v25, 0xffff0000, v25
  v_lshlrev_b32 v26, 16, v27
  v_and_b32 v27, 0xffff0000, v27
  v_lshlrev_b32 v28, 16, v29
  v_and_b32 v29, 0xffff0000, v29
  v_lshlrev_b32 v30, 16, v31
  v_and_b32 v31, 0xffff0000, v31
  v_pk_mul_f32 v[24:25], v[24:25], v[34:35] op_sel_hi:[1,0]
  v_pk_mul_f32 v[26:27], v[26:27], v[34:35] op_sel_hi:[1,0]
  v_pk_mul_f32 v[28:29], v[28:29], v[34:35] op_sel_hi:[1,0]
  v_pk_mul_f32 v[30:31], v[30:31], v[34:35] op_sel_hi:[1,0]
  v_cvt_pk_bf16_f32 v20, v24, v25
  v_cvt_pk_bf16_f32 v21, v26, v27
  v_cvt_pk_bf16_f32 v22, v28, v29
  v_cvt_pk_bf16_f32 v23, v30, v31
  v_mov_b64_dpp v[64:65], v[20:21] row_newbcast:0 row_mask:0xf bank_mask:0xf
  s_nop 0
  v_mov_b64_dpp v[66:67], v[22:23] row_newbcast:0 row_mask:0xf bank_mask:0xf
  v_mov_b64_dpp v[68:69], v[20:21] row_newbcast:1 row_mask:0xf bank_mask:0xf
  v_mov_b64_dpp v[70:71], v[22:23] row_newbcast:1 row_mask:0xf bank_mask:0xf
  v_mfma_f32_16x16x32_bf16 v[8:11], v[128:131], v[64:67], 0
  v_mov_b64_dpp v[72:73], v[20:21] row_newbcast:2 row_mask:0xf bank_mask:0xf
  v_mov_b64_dpp v[74:75], v[22:23] row_newbcast:2 row_mask:0xf bank_mask:0xf
  v_mfma_f32_16x16x32_bf16 v[8:11], v[132:135], v[68:71], v[8:11]
  v_mov_b64_dpp v[64:65], v[20:21] row_newbcast:3 row_mask:0xf bank_mask:0xf
  v_mov_b64_dpp v[66:67], v[22:23] row_newbcast:3 row_mask:0xf bank_mask:0xf
  v_mfma_f32_16x16x32_bf16 v[8:11], v[136:139], v[72:75], v[8:11]
  v_mov_b64_dpp v[68:69], v[20:21] row_newbcast:4 row_mask:0xf bank_mask:0xf
  v_mov_b64_dpp v[70:71], v[22:23] row_newbcast:4 row_mask:0xf bank_mask:0xf
  v_mfma_f32_16x16x32_bf16 v[8:11], v[140:143], v[64:67], v[8:11]
  v_mov_b64_dpp v[72:73], v[20:21] row_newbcast:5 row_mask:0xf bank_mask:0xf
  v_mov_b64_dpp v[74:75], v[22:23] row_newbcast:5 row_mask:0xf bank_mask:0xf
  v_mfma_f32_16x16x32_bf16 v[8:11], v[144:147], v[68:71], v[8:11]
  v_mov_b64_dpp v[64:65], v[20:21] row_newbcast:6 row_mask:0xf bank_mask:0xf
  v_mov_b64_dpp v[66:67], v[22:23] row_newbcast:6 row_mask:0xf bank_mask:0xf
  v_mfma_f32_16x16x32_bf16 v[8:11], v[148:151], v[72:75], v[8:11]
  v_mov_b64_dpp v[68:69], v[20:21] row_newbcast:7 row_mask:0xf bank_mask:0xf
  v_mov_b64_dpp v[70:71], v[22:23] row_newbcast:7 row_mask:0xf bank_mask:0xf
  v_mfma_f32_16x16x32_bf16 v[8:11], v[152:155], v[64:67], v[8:11]
  v_mov_b64_dpp v[72:73], v[20:21] row_newbcast:8 row_mask:0xf bank_mask:0xf
  v_mov_b64_dpp v[74:75], v[22:23] row_newbcast:8 row_mask:0xf bank_mask:0xf
  v_mfma_f32_16x16x32_bf16 v[8:11], v[156:159], v[68:71], v[8:11]
  v_mov_b64_dpp v[64:65], v[20:21] row_newbcast:9 row_mask:0xf bank_mask:0xf
  v_mov_b64_dpp v[66:67], v[22:23] row_newbcast:9 row_mask:0xf bank_mask:0xf
  v_mfma_f32_16x16x32_bf16 v[8:11], v[160:163], v[72:75], v[8:11]
  v_mov_b64_dpp v[68:69], v[20:21] row_newbcast:10 row_mask:0xf bank_mask:0xf
  v_mov_b64_dpp v[70:71], v[22:23] row_newbcast:10 row_mask:0xf bank_mask:0xf
  v_mfma_f32_16x16x32_bf16 v[8:11], v[164:167], v[64:67], v[8:11]
  v_mov_b64_dpp v[72:73], v[20:21] row_newbcast:11 row_mask:0xf bank_mask:0xf
  v_mov_b64_dpp v[74:75], v[22:23] row_newbcast:11 row_mask:0xf bank_mask:0xf
  v_mfma_f32_16x16x32_bf16 v[8:11], v[168:171], v[68:71], v[8:11]
  v_mov_b64_dpp v[64:65], v[20:21] row_newbcast:12 row_mask:0xf bank_mask:0xf
  v_mov_b64_dpp v[66:67], v[22:23] row_newbcast:12 row_mask:0xf bank_mask:0xf
  v_mfma_f32_16x16x32_bf16 v[8:11], v[172:175], v[72:75], v[8:11]
  v_mov_b64_dpp v[68:69], v[20:21] row_newbcast:13 row_mask:0xf bank_mask:0xf
  v_mov_b64_dpp v[70:71], v[22:23] row_newbcast:13 row_mask:0xf bank_mask:0xf
  v_mfma_f32_16x16x32_bf16 v[8:11], v[176:179], v[64:67], v[8:11]
  s_nop 0
  v_mfma_f32_16x16x32_bf16 v[8:11], v[180:183], v[68:71], v[8:11]
  ds_read_u16 v43, v43
  s_mov_b32 s55, 524288
L_cf4:
  s_cbranch_execz L_cf3
  s_nop 4
  v_cndmask_b32 v8, v8, v9, s[4:5]
  v_cndmask_b32 v8, v8, v10, s[6:7]
  v_cndmask_b32 v8, v8, v11, s[8:9]
  v_cvt_pk_bf16_f32 v8, v8, v8
  v_lshlrev_b32 v8, 16, v8
  v_add_f32 v8, v8, v46
  v_max_f32 v8, 0, v8
  v_cvt_pk_bf16_f32 v8, v8, v8
  v_lshlrev_b32 v8, 16, v8
  v_mul_f32 v8, v8, v8
  v_cvt_pk_bf16_f32 v8, v8, v8
  ds_write_b16 v57, v8
  s_waitcnt lgkmcnt(0)
  s_barrier
  ds_read_b128 v[64:67], v53
  ds_read_b128 v[68:71], v53 offset:64
  s_cmp_eq_u32 s82, 0
  s_waitcnt lgkmcnt(1)
  v_mfma_f32_16x16x32_bf16 v[8:11], v[192:195], v[64:67], 0
  s_waitcnt lgkmcnt(0)
  v_mfma_f32_16x16x32_bf16 v[8:11], v[196:199], v[68:71], v[8:11]
  v_mfma_f32_16x16x32_bf16 v[72:75], v[200:203], v[64:67], 0
  v_mfma_f32_16x16x32_bf16 v[72:75], v[204:207], v[68:71], v[72:75]
  s_nop 1
  v_mfma_f32_16x16x32_bf16 v[76:79], v[208:211], v[64:67], 0
  s_nop 1
  v_mfma_f32_16x16x32_bf16 v[76:79], v[212:215], v[68:71], v[76:79]
  s_nop 1
  v_mfma_f32_16x16x32_bf16 v[80:83], v[216:219], v[64:67], 0
  v_cndmask_b32 v8, v8, v72, s[10:11]
  v_cndmask_b32 v9, v9, v73, s[10:11]
  v_mfma_f32_16x16x32_bf16 v[80:83], v[220:223], v[68:71], v[80:83]
  v_cndmask_b32 v10, v10, v74, s[10:11]
  v_cndmask_b32 v11, v11, v75, s[10:11]
  v_mfma_f32_16x16x32_bf16 v[84:87], v[224:227], v[64:67], 0
  v_cndmask_b32 v8, v8, v76, s[12:13]
  v_cndmask_b32 v9, v9, v77, s[12:13]
  v_mfma_f32_16x16x32_bf16 v[84:87], v[228:231], v[68:71], v[84:87]
  v_cndmask_b32 v10, v10, v78, s[12:13]
  v_cndmask_b32 v11, v11, v79, s[12:13]
  v_mfma_f32_16x16x32_bf16 v[88:91], v[232:235], v[64:67], 0
  v_cndmask_b32 v8, v8, v80, s[14:15]
  v_cndmask_b32 v9, v9, v81, s[14:15]
  v_mfma_f32_16x16x32_bf16 v[88:91], v[236:239], v[68:71], v[88:91]
  v_cndmask_b32 v10, v10, v82, s[14:15]
  v_cndmask_b32 v11, v11, v83, s[14:15]
  v_mfma_f32_16x16x32_bf16 v[92:95], v[240:243], v[64:67], 0
  v_cndmask_b32 v8, v8, v84, s[16:17]
  v_cndmask_b32 v9, v9, v85, s[16:17]
  v_mfma_f32_16x16x32_bf16 v[92:95], v[244:247], v[68:71], v[92:95]
  v_cndmask_b32 v10, v10, v86, s[16:17]
  v_cndmask_b32 v11, v11, v87, s[16:17]
  v_cndmask_b32 v8, v8, v88, s[18:19]
  v_cndmask_b32 v9, v9, v89, s[18:19]
  v_cndmask_b32 v10, v10, v90, s[18:19]
  v_cndmask_b32 v11, v11, v91, s[18:19]
  s_mov_b32 exec_lo, 0x7f007f
  s_mov_b32 exec_hi, 0x7f007f
  v_cndmask_b32 v8, v8, v92, s[20:21]
  v_cndmask_b32 v9, v9, v93, s[20:21]
  v_cndmask_b32 v10, v10, v94, s[20:21]
  v_cndmask_b32 v11, v11, v95, s[20:21]
  v_bfi_b32 v8, s58, v59, v8
  s_cbranch_scc1 L_Pfar
  global_store_dwordx4 v56, v[8:11], s[28:29]
L_Pdone:
  s_mov_b64 exec, -1
  s_cmp_lg_u32 s3, 1
  s_cbranch_scc1 L_fin
  global_load_dwordx4 v[128:131], v40, s[28:29] sc1
  global_load_dwordx4 v[132:135], v41, s[28:29] sc1
  v_lshlrev_b32 v43, 16, v43
L_ppoll:
  global_load_dwordx4 v[136:139], v40, s[28:29] sc1
  global_load_dwordx4 v[140:143], v41, s[28:29] sc1
  s_waitcnt vmcnt(2)
  v_xor_b32 v128, s53, v128
  v_xor_b32 v132, s53, v132
  v_pk_fma_f32 v[18:19], v[134:135], v[44:45], v[130:131] op_sel_hi:[1,0,1]
  v_pk_fma_f32 v[16:17], v[132:133], v[44:45], v[128:129] op_sel_hi:[1,0,1]
  v_bitop3_b32 v24, v128, s58, v132 bitop3:0xc8
  v_cmp_ne_u32 vcc, 0, v24
  v_permlane32_swap_b32 v16, v18
  v_permlane32_swap_b32 v17, v19
  s_cbranch_vccz L_pgot
  global_load_dwordx4 v[128:131], v40, s[28:29] sc1
  global_load_dwordx4 v[132:135], v41, s[28:29] sc1
  s_waitcnt vmcnt(2)
  v_xor_b32 v136, s53, v136
  v_xor_b32 v140, s53, v140
  v_pk_fma_f32 v[18:19], v[142:143], v[44:45], v[138:139] op_sel_hi:[1,0,1]
  v_pk_fma_f32 v[16:17], v[140:141], v[44:45], v[136:137] op_sel_hi:[1,0,1]
  v_bitop3_b32 v24, v136, s58, v140 bitop3:0xc8
  v_cmp_ne_u32 vcc, 0, v24
  v_permlane32_swap_b32 v16, v18
  v_permlane32_swap_b32 v17, v19
  s_cbranch_vccz L_pgot
  s_sub_u32 s55, s55, 1
  s_cbranch_scc0 L_ppoll
L_pgot:
  v_pk_add_f32 v[16:17], v[16:17], v[18:19]
  s_nop 1
  v_permlane16_swap_b32 v16, v17
  v_add_f32 v16, v16, v17
  s_nop 1
  v_add_f32_dpp v16, v16, v16 row_ror:4 row_mask:0xf bank_mask:0xf
  s_nop 1
  v_add_f32_dpp v16, v16, v16 row_ror:8 row_mask:0xf bank_mask:0xf
  v_cvt_pk_bf16_f32 v16, v16, v16
  v_lshlrev_b32 v16, 16, v16
  v_add_f32 v16, v16, v62
  v_cvt_pk_bf16_f32 v16, v16, v16
  v_lshlrev_b32 v16, 16, v16
  v_add_f32 v16, v16, v43
  s_mov_b32 exec_lo, 0xf000f
  s_mov_b32 exec_hi, 0xf000f
  v_cvt_pk_bf16_f32 v16, v16, v16
  global_store_short v42, v16, s[24:25]
  s_cmp_lg_u32 s35, 0
  s_cbranch_scc1 L_fin
  s_mov_b64 exec, 1
  global_store_dword v45, v59, s[28:29]
L_fin:
L_end:
  s_endpgm
L_cf_end:
L_Pfar:
  global_store_dwordx4 v56, v[8:11], s[28:29] sc1
  s_branch L_Pdone
.p2align 8
.type L_tab,@object
L_tab:
.byte 123, 123, 123, 123, 123, 123, 123, 123, 123, 123, 123, 123, 123, 123, 123, 123
.byte 123, 123, 123, 123, 123, 123, 123, 123, 123, 123, 123, 123, 123, 123, 123, 123
.byte 123, 123, 123, 123, 123, 123, 123, 123, 123, 123, 123, 123, 123, 123, 123, 123
.byte 123, 123, 123, 123, 123, 123, 123, 123, 123, 123, 123, 123, 123, 123, 123, 123
.byte 123, 123, 123, 123, 123, 123, 123, 123, 123, 123, 123, 123, 123, 123, 123, 123
.byte 123, 123, 123, 123, 123, 123, 123, 123, 123, 123, 123, 123, 123, 123, 123, 123
.byte 123, 123, 123, 123, 123, 123, 123, 123, 123, 123, 123, 123, 123, 123, 123, 123
.byte 123, 123, 119, 119, 123, 123, 119, 119, 123, 123, 119, 119, 123, 123, 119, 119
.byte 123, 123, 119, 119, 123, 123, 119, 119, 123, 123, 119, 119, 123, 123, 119, 119
.byte 123, 123, 119, 119, 123, 123, 119, 119, 123, 123, 119, 119, 123, 123, 119, 119
.byte 123, 123, 119, 119, 123, 123, 119, 119, 123, 123, 119, 119, 123, 123, 119, 119
.byte 123, 123, 119, 119, 123, 123, 119, 119, 123, 123, 119, 119, 123, 123, 119, 119
.byte 123, 123, 119, 119, 123, 123, 119, 119, 123, 123, 119, 119, 123, 123, 119, 119
.byte 123, 123, 119, 119, 123, 123, 119, 119, 123, 123, 119, 119, 123, 123, 119, 119
.byte 123, 123, 119, 119, 123, 123, 119, 119, 123, 123, 119, 119, 123, 123, 119, 119
.byte 123, 123, 123, 123, 123, 123, 123, 123, 123, 123, 123, 123, 123, 123, 123, 123
.short 20376, 22424, 28568, 30616, 20256, 22304, 28448, 30496, 20264, 22312, 28456, 30504, 20272, 22320, 28464, 30512
.short 1848, 3896, 5944, 7992, 10040, 12088, 14136, 16184, 18232, 20280, 22328, 24376, 26424, 28472, 30520, 32568
.short 1952, 4000, 6048, 8096, 10144, 12192, 14240, 16288, 18336, 20384, 22432, 24480, 26528, 28576, 30624, 32672
.short 1960, 4008, 6056, 8104, 10152, 12200, 14248, 16296, 18344, 20392, 22440, 24488, 26536, 28584, 30632, 32680
.short 1968, 4016, 6064, 8112, 10160, 12208, 14256, 16304, 18352, 20400, 22448, 24496, 26544, 28592, 30640, 32688
.short 1976, 4024, 6072, 8120, 10168, 12216, 14264, 16312, 18360, 20408, 22456, 24504, 26552, 28600, 30648, 32696
.short 0, 0, 0, 0, 0, 0, 0, 0, 0, 0, 0, 0, 0, 0, 0, 0
.short 0, 0, 0, 0, 0, 0, 0, 0, 0, 0, 0, 0, 0, 0, 0, 0
.short 16280, 22424, 24472, 30616, 16160, 22304, 24352, 30496, 16168, 22312, 24360, 30504, 16176, 22320, 24368, 30512
.short 1848, 3896, 5944, 7992, 10040, 12088, 14136, 16184, 18232, 20280, 22328, 24376, 26424, 28472, 30520, 32568
.short 1952, 4000, 6048, 8096, 10144, 12192, 14240, 16288, 18336, 20384, 22432, 24480, 26528, 28576, 30624, 32672
.short 1960, 4008, 6056, 8104, 10152, 12200, 14248, 16296, 18344, 20392, 22440, 24488, 26536, 28584, 30632, 32680
.short 1968, 4016, 6064, 8112, 10160, 12208, 14256, 16304, 18352, 20400, 22448, 24496, 26544, 28592, 30640, 32688
.short 1976, 4024, 6072, 8120, 10168, 12216, 14264, 16312, 18360, 20408, 22456, 24504, 26552, 28600, 30648, 32696
.short 0, 0, 0, 0, 0, 0, 0, 0, 0, 0, 0, 0, 0, 0, 0, 0
.short 0, 0, 0, 0, 0, 0, 0, 0, 0, 0, 0, 0, 0, 0, 0, 0
.short 16280, 18328, 24472, 26520, 16160, 18208, 24352, 26400, 16168, 18216, 24360, 26408, 16176, 18224, 24368, 26416
.short 1848, 3896, 5944, 7992, 10040, 12088, 14136, 16184, 18232, 20280, 22328, 24376, 26424, 28472, 30520, 32568
.short 1952, 4000, 6048, 8096, 10144, 12192, 14240, 16288, 18336, 20384, 22432, 24480, 26528, 28576, 30624, 32672
.short 1960, 4008, 6056, 8104, 10152, 12200, 14248, 16296, 18344, 20392, 22440, 24488, 26536, 28584, 30632, 32680
.short 1968, 4016, 6064, 8112, 10160, 12208, 14256, 16304, 18352, 20400, 22448, 24496, 26544, 28592, 30640, 32688
.short 1976, 4024, 6072, 8120, 10168, 12216, 14264, 16312, 18360, 20408, 22456, 24504, 26552, 28600, 30648, 32696
.short 0, 0, 0, 0, 0, 0, 0, 0, 0, 0, 0, 0, 0, 0, 0, 0
.short 0, 0, 0, 0, 0, 0, 0, 0, 0, 0, 0, 0, 0, 0, 0, 0
.short 18328, 20376, 26520, 28568, 18208, 20256, 26400, 28448, 18216, 20264, 26408, 28456, 18224, 20272, 26416, 28464
.short 1848, 3896, 5944, 7992, 10040, 12088, 14136, 16184, 18232, 20280, 22328, 24376, 26424, 28472, 30520, 32568
.short 1952, 4000, 6048, 8096, 10144, 12192, 14240, 16288, 18336, 20384, 22432, 24480, 26528, 28576, 30624, 32672
.short 1960, 4008, 6056, 8104, 10152, 12200, 14248, 16296, 18344, 20392, 22440, 24488, 26536, 28584, 30632, 32680
.short 1968, 4016, 6064, 8112, 10160, 12208, 14256, 16304, 18352, 20400, 22448, 24496, 26544, 28592, 30640, 32688
.short 1976, 4024, 6072, 8120, 10168, 12216, 14264, 16312, 18360, 20408, 22456, 24504, 26552, 28600, 30648, 32696
.short 0, 0, 0, 0, 0, 0, 0, 0, 0, 0, 0, 0, 0, 0, 0, 0
.short 0, 0, 0, 0, 0, 0, 0, 0, 0, 0, 0, 0, 0, 0, 0, 0
.short 20376, 22424, 28568, 30616, 20256, 22304, 28448, 30496, 20264, 22312, 28456, 30504, 20272, 22320, 28464, 30512
.short 1848, 3896, 5944, 7992, 10040, 12088, 14136, 16184, 18232, 20280, 22328, 24376, 26424, 28472, 30520, 32568
.short 1952, 4000, 6048, 8096, 10144, 12192, 14240, 16288, 18336, 20384, 22432, 24480, 26528, 28576, 30624, 32672
.short 1960, 4008, 6056, 8104, 10152, 12200, 14248, 16296, 18344, 20392, 22440, 24488, 26536, 28584, 30632, 32680
.short 1968, 4016, 6064, 8112, 10160, 12208, 14256, 16304, 18352, 20400, 22448, 24496, 26544, 28592, 30640, 32688
.short 1976, 4024, 6072, 8120, 10168, 12216, 14264, 16312, 18360, 20408, 22456, 24504, 26552, 28600, 30648, 32696
.short 0, 0, 0, 0, 0, 0, 0, 0, 0, 0, 0, 0, 0, 0, 0, 0
.short 0, 0, 0, 0, 0, 0, 0, 0, 0, 0, 0, 0, 0, 0, 0, 0
.short 16280, 22424, 24472, 30616, 16160, 22304, 24352, 30496, 16168, 22312, 24360, 30504, 16176, 22320, 24368, 30512
.short 1848, 3896, 5944, 7992, 10040, 12088, 14136, 16184, 18232, 20280, 22328, 24376, 26424, 28472, 30520, 32568
.short 1952, 4000, 6048, 8096, 10144, 12192, 14240, 16288, 18336, 20384, 22432, 24480, 26528, 28576, 30624, 32672
.short 1960, 4008, 6056, 8104, 10152, 12200, 14248, 16296, 18344, 20392, 22440, 24488, 26536, 28584, 30632, 32680
.short 1968, 4016, 6064, 8112, 10160, 12208, 14256, 16304, 18352, 20400, 22448, 24496, 26544, 28592, 30640, 32688
.short 1976, 4024, 6072, 8120, 10168, 12216, 14264, 16312, 18360, 20408, 22456, 24504, 26552, 28600, 30648, 32696
.short 0, 0, 0, 0, 0, 0, 0, 0, 0, 0, 0, 0, 0, 0, 0, 0
.short 0, 0, 0, 0, 0, 0, 0, 0, 0, 0, 0, 0, 0, 0, 0, 0
.short 16280, 18328, 24472, 26520, 16160, 18208, 24352, 26400, 16168, 18216, 24360, 26408, 16176, 18224, 24368, 26416
.short 1848, 3896, 5944, 7992, 10040, 12088, 14136, 16184, 18232, 20280, 22328, 24376, 26424, 28472, 30520, 32568
.short 1952, 4000, 6048, 8096, 10144, 12192, 14240, 16288, 18336, 20384, 22432, 24480, 26528, 28576, 30624, 32672
.short 1960, 4008, 6056, 8104, 10152, 12200, 14248, 16296, 18344, 20392, 22440, 24488, 26536, 28584, 30632, 32680
.short 1968, 4016, 6064, 8112, 10160, 12208, 14256, 16304, 18352, 20400, 22448, 24496, 26544, 28592, 30640, 32688
.short 1976, 4024, 6072, 8120, 10168, 12216, 14264, 16312, 18360, 20408, 22456, 24504, 26552, 28600, 30648, 32696
.short 0, 0, 0, 0, 0, 0, 0, 0, 0, 0, 0, 0, 0, 0, 0, 0
.short 0, 0, 0, 0, 0, 0, 0, 0, 0, 0, 0, 0, 0, 0, 0, 0
.short 18328, 20376, 26520, 28568, 18208, 20256, 26400, 28448, 18216, 20264, 26408, 28456, 18224, 20272, 26416, 28464
.short 1848, 3896, 5944, 7992, 10040, 12088, 14136, 16184, 18232, 20280, 22328, 24376, 26424, 28472, 30520, 32568
.short 1952, 4000, 6048, 8096, 10144, 12192, 14240, 16288, 18336, 20384, 22432, 24480, 26528, 28576, 30624, 32672
.short 1960, 4008, 6056, 8104, 10152, 12200, 14248, 16296, 18344, 20392, 22440, 24488, 26536, 28584, 30632, 32680
.short 1968, 4016, 6064, 8112, 10160, 12208, 14256, 16304, 18352, 20400, 22448, 24496, 26544, 28592, 30640, 32688
.short 1976, 4024, 6072, 8120, 10168, 12216, 14264, 16312, 18360, 20408, 22456, 24504, 26552, 28600, 30648, 32696
.short 0, 0, 0, 0, 0, 0, 0, 0, 0, 0, 0, 0, 0, 0, 0, 0
.short 0, 0, 0, 0, 0, 0, 0, 0, 0, 0, 0, 0, 0, 0, 0, 0
.short 20376, 22424, 28568, 30616, 20256, 22304, 28448, 30496, 20264, 22312, 28456, 30504, 20272, 22320, 28464, 30512
.short 1848, 3896, 5944, 7992, 10040, 12088, 14136, 16184, 18232, 20280, 22328, 24376, 26424, 28472, 30520, 32568
.short 1952, 4000, 6048, 8096, 10144, 12192, 14240, 16288, 18336, 20384, 22432, 24480, 26528, 28576, 30624, 32672
.short 1960, 4008, 6056, 8104, 10152, 12200, 14248, 16296, 18344, 20392, 22440, 24488, 26536, 28584, 30632, 32680
.short 1968, 4016, 6064, 8112, 10160, 12208, 14256, 16304, 18352, 20400, 22448, 24496, 26544, 28592, 30640, 32688
.short 1976, 4024, 6072, 8120, 10168, 12216, 14264, 16312, 18360, 20408, 22456, 24504, 26552, 28600, 30648, 32696
.short 0, 0, 0, 0, 0, 0, 0, 0, 0, 0, 0, 0, 0, 0, 0, 0
.short 0, 0, 0, 0, 0, 0, 0, 0, 0, 0, 0, 0, 0, 0, 0, 0
.short 16280, 22424, 24472, 30616, 16160, 22304, 24352, 30496, 16168, 22312, 24360, 30504, 16176, 22320, 24368, 30512
.short 1848, 3896, 5944, 7992, 10040, 12088, 14136, 16184, 18232, 20280, 22328, 24376, 26424, 28472, 30520, 32568
.short 1952, 4000, 6048, 8096, 10144, 12192, 14240, 16288, 18336, 20384, 22432, 24480, 26528, 28576, 30624, 32672
.short 1960, 4008, 6056, 8104, 10152, 12200, 14248, 16296, 18344, 20392, 22440, 24488, 26536, 28584, 30632, 32680
.short 1968, 4016, 6064, 8112, 10160, 12208, 14256, 16304, 18352, 20400, 22448, 24496, 26544, 28592, 30640, 32688
.short 1976, 4024, 6072, 8120, 10168, 12216, 14264, 16312, 18360, 20408, 22456, 24504, 26552, 28600, 30648, 32696
.short 0, 0, 0, 0, 0, 0, 0, 0, 0, 0, 0, 0, 0, 0, 0, 0
.short 0, 0, 0, 0, 0, 0, 0, 0, 0, 0, 0, 0, 0, 0, 0, 0
.short 16280, 18328, 24472, 26520, 16160, 18208, 24352, 26400, 16168, 18216, 24360, 26408, 16176, 18224, 24368, 26416
.short 1848, 3896, 5944, 7992, 10040, 12088, 14136, 16184, 18232, 20280, 22328, 24376, 26424, 28472, 30520, 32568
.short 1952, 4000, 6048, 8096, 10144, 12192, 14240, 16288, 18336, 20384, 22432, 24480, 26528, 28576, 30624, 32672
.short 1960, 4008, 6056, 8104, 10152, 12200, 14248, 16296, 18344, 20392, 22440, 24488, 26536, 28584, 30632, 32680
.short 1968, 4016, 6064, 8112, 10160, 12208, 14256, 16304, 18352, 20400, 22448, 24496, 26544, 28592, 30640, 32688
.short 1976, 4024, 6072, 8120, 10168, 12216, 14264, 16312, 18360, 20408, 22456, 24504, 26552, 28600, 30648, 32696
.short 0, 0, 0, 0, 0, 0, 0, 0, 0, 0, 0, 0, 0, 0, 0, 0
.short 0, 0, 0, 0, 0, 0, 0, 0, 0, 0, 0, 0, 0, 0, 0, 0
.short 18328, 20376, 26520, 28568, 18208, 20256, 26400, 28448, 18216, 20264, 26408, 28456, 18224, 20272, 26416, 28464
.short 1848, 3896, 5944, 7992, 10040, 12088, 14136, 16184, 18232, 20280, 22328, 24376, 26424, 28472, 30520, 32568
.short 1952, 4000, 6048, 8096, 10144, 12192, 14240, 16288, 18336, 20384, 22432, 24480, 26528, 28576, 30624, 32672
.short 1960, 4008, 6056, 8104, 10152, 12200, 14248, 16296, 18344, 20392, 22440, 24488, 26536, 28584, 30632, 32680
.short 1968, 4016, 6064, 8112, 10160, 12208, 14256, 16304, 18352, 20400, 22448, 24496, 26544, 28592, 30640, 32688
.short 1976, 4024, 6072, 8120, 10168, 12216, 14264, 16312, 18360, 20408, 22456, 24504, 26552, 28600, 30648, 32696
.short 0, 0, 0, 0, 0, 0, 0, 0, 0, 0, 0, 0, 0, 0, 0, 0
.short 0, 0, 0, 0, 0, 0, 0, 0, 0, 0, 0, 0, 0, 0, 0, 0
.short 20376, 22424, 28568, 30616, 20256, 22304, 28448, 30496, 20264, 22312, 28456, 30504, 20272, 22320, 28464, 30512
.short 1848, 3896, 5944, 7992, 10040, 12088, 14136, 16184, 18232, 20280, 22328, 24376, 26424, 28472, 30520, 32568
.short 1952, 4000, 6048, 8096, 10144, 12192, 14240, 16288, 18336, 20384, 22432, 24480, 26528, 28576, 30624, 32672
.short 1960, 4008, 6056, 8104, 10152, 12200, 14248, 16296, 18344, 20392, 22440, 24488, 26536, 28584, 30632, 32680
.short 1968, 4016, 6064, 8112, 10160, 12208, 14256, 16304, 18352, 20400, 22448, 24496, 26544, 28592, 30640, 32688
.short 1976, 4024, 6072, 8120, 10168, 12216, 14264, 16312, 18360, 20408, 22456, 24504, 26552, 28600, 30648, 32696
.short 0, 0, 0, 0, 0, 0, 0, 0, 0, 0, 0, 0, 0, 0, 0, 0
.short 0, 0, 0, 0, 0, 0, 0, 0, 0, 0, 0, 0, 0, 0, 0, 0
.short 16280, 22424, 24472, 30616, 16160, 22304, 24352, 30496, 16168, 22312, 24360, 30504, 16176, 22320, 24368, 30512
.short 1848, 3896, 5944, 7992, 10040, 12088, 14136, 16184, 18232, 20280, 22328, 24376, 26424, 28472, 30520, 32568
.short 1952, 4000, 6048, 8096, 10144, 12192, 14240, 16288, 18336, 20384, 22432, 24480, 26528, 28576, 30624, 32672
.short 1960, 4008, 6056, 8104, 10152, 12200, 14248, 16296, 18344, 20392, 22440, 24488, 26536, 28584, 30632, 32680
.short 1968, 4016, 6064, 8112, 10160, 12208, 14256, 16304, 18352, 20400, 22448, 24496, 26544, 28592, 30640, 32688
.short 1976, 4024, 6072, 8120, 10168, 12216, 14264, 16312, 18360, 20408, 22456, 24504, 26552, 28600, 30648, 32696
.short 0, 0, 0, 0, 0, 0, 0, 0, 0, 0, 0, 0, 0, 0, 0, 0
.short 0, 0, 0, 0, 0, 0, 0, 0, 0, 0, 0, 0, 0, 0, 0, 0
.short 16280, 18328, 24472, 26520, 16160, 18208, 24352, 26400, 16168, 18216, 24360, 26408, 16176, 18224, 24368, 26416
.short 1848, 3896, 5944, 7992, 10040, 12088, 14136, 16184, 18232, 20280, 22328, 24376, 26424, 28472, 30520, 32568
.short 1952, 4000, 6048, 8096, 10144, 12192, 14240, 16288, 18336, 20384, 22432, 24480, 26528, 28576, 30624, 32672
.short 1960, 4008, 6056, 8104, 10152, 12200, 14248, 16296, 18344, 20392, 22440, 24488, 26536, 28584, 30632, 32680
.short 1968, 4016, 6064, 8112, 10160, 12208, 14256, 16304, 18352, 20400, 22448, 24496, 26544, 28592, 30640, 32688
.short 1976, 4024, 6072, 8120, 10168, 12216, 14264, 16312, 18360, 20408, 22456, 24504, 26552, 28600, 30648, 32696
.short 0, 0, 0, 0, 0, 0, 0, 0, 0, 0, 0, 0, 0, 0, 0, 0
.short 0, 0, 0, 0, 0, 0, 0, 0, 0, 0, 0, 0, 0, 0, 0, 0
.short 18328, 20376, 26520, 28568, 18208, 20256, 26400, 28448, 18216, 20264, 26408, 28456, 18224, 20272, 26416, 28464
.short 1848, 3896, 5944, 7992, 10040, 12088, 14136, 16184, 18232, 20280, 22328, 24376, 26424, 28472, 30520, 32568
.short 1952, 4000, 6048, 8096, 10144, 12192, 14240, 16288, 18336, 20384, 22432, 24480, 26528, 28576, 30624, 32672
.short 1960, 4008, 6056, 8104, 10152, 12200, 14248, 16296, 18344, 20392, 22440, 24488, 26536, 28584, 30632, 32680
.short 1968, 4016, 6064, 8112, 10160, 12208, 14256, 16304, 18352, 20400, 22448, 24496, 26544, 28592, 30640, 32688
.short 1976, 4024, 6072, 8120, 10168, 12216, 14264, 16312, 18360, 20408, 22456, 24504, 26552, 28600, 30648, 32696
.short 0, 0, 0, 0, 0, 0, 0, 0, 0, 0, 0, 0, 0, 0, 0, 0
.short 0, 0, 0, 0, 0, 0, 0, 0, 0, 0, 0, 0, 0, 0, 0, 0
.size L_tab, 4352
.section .rodata,"a"
.p2align 6
.amdhsa_kernel sequential_preLN__gqa_block_cached__dense_activation_squared_relu__decode_kernel
  .amdhsa_next_free_vgpr 512
  .amdhsa_next_free_sgpr 96
  .amdhsa_accum_offset 256
  .amdhsa_group_segment_fixed_size 0
  .amdhsa_kernarg_size 104
  .amdhsa_user_sgpr_count 2
  .amdhsa_user_sgpr_kernarg_segment_ptr 1
  .amdhsa_system_sgpr_workgroup_id_x 1
  .amdhsa_float_denorm_mode_32 3
.end_amdhsa_kernel
```
